```python
import torch

def _softmax(x, axis=-1):
    return torch.softmax(x, dim=axis)
def _gelu(x):
    return torch.nn.functional.gelu(x, approximate="tanh")
def _silu(x):
    return torch.nn.functional.silu(x)
def _sigmoid(x):
    return torch.sigmoid(x)
def _layernorm(x, axis=-1, eps=1e-5):
    m = x.mean(dim=axis, keepdim=True)
    v = x.var(dim=axis, keepdim=True, unbiased=False)
    return (x - m) / torch.sqrt(v + eps)
def _scatter_add(tgt, idx, src, axis=0):
    return tgt.clone().index_add_(axis, idx, src)
def _segment_sum(src, seg, n):
    out = torch.zeros((n,) + src.shape[1:], dtype=src.dtype)
    return out.index_add_(0, seg, src)
def _pad(x, pw):
    flat = tuple(v for pair in reversed(pw) for v in pair)
    return torch.nn.functional.pad(x, flat)

kernel_name = 'sequential_preLN__sliding_block__glu_gated_bilinear__prompt'

def setup_inputs():

    _w = (lambda a: (lambda t: t.to(torch.bfloat16) if t.is_floating_point() else t)(torch.as_tensor(a)))
    def _A_setup():
        B, S, D = 1, 2048, 640
        return {
            "x": _w((lambda *s: torch.randn(*s, dtype=torch.bfloat16) * 0.05)(B, S, D)),
            "wqkv": _w((lambda *s: torch.randn(*s, dtype=torch.bfloat16) * 0.05)(D, 3 * D)),
            "wo": _w((lambda *s: torch.randn(*s, dtype=torch.bfloat16) * 0.05)(D, D)),
        }
    _A_in = _A_setup()

    def _B_setup():
        B, S, D, F = 1, 2048, 640, 1536
        return {
            "x": _w((lambda *s: torch.randn(*s, dtype=torch.bfloat16) * 0.05)(B, S, D)),
            "w_gate": _w((lambda *s: torch.randn(*s, dtype=torch.bfloat16) * 0.8)(D, F) * (D ** -0.5)),
            "w_up": _w((lambda *s: torch.randn(*s, dtype=torch.bfloat16) * 0.8)(D, F) * (D ** -0.5)),
            "w_down": _w((lambda *s: torch.randn(*s, dtype=torch.bfloat16) * 0.8)(F, D) * (F ** -0.5)),
        }
    _B_in = _B_setup()

    return {
        "A_x": _A_in["x"],
        "A_wqkv": _A_in["wqkv"],
        "A_wo": _A_in["wo"],
        "B_x": _B_in["x"],
        "B_w_gate": _B_in["w_gate"],
        "B_w_up": _B_in["w_up"],
        "B_w_down": _B_in["w_down"],
    }

def reference(A_x, A_wqkv, A_wo, B_x, B_w_gate, B_w_up, B_w_down):
    def _A_ref(x, wqkv, wo):
        B, S, D = x.shape
        H = 32; Dh = D // H; W = 256
        qkv = (lambda x, *d: x.permute(*d))((x @ wqkv).reshape(B, S, 3, H, Dh), 2, 0, 3, 1, 4)
        q, k, v = qkv[0], qkv[1], qkv[2]
        scores = torch.einsum("bhqd,bhkd->bhqk", q, k) * (Dh ** -0.5)
        idx = torch.arange(S)
        mask = (idx[:, None] - idx[None, :] >= 0) & (idx[:, None] - idx[None, :] < W)
        scores = torch.where(mask[None, None], scores, -1e9)
        p = _softmax(scores, axis=-1)
        o = torch.einsum("bhqk,bhkd->bhqd", p, v)
        return (lambda x, *d: x.permute(*d))(o, 0, 2, 1, 3).reshape(B, S, D) @ wo

    def _B_ref(x, w_gate, w_up, w_down):
        g = torch.einsum("bsd,df->bsf", x, w_gate)
        u = torch.einsum("bsd,df->bsf", x, w_up)
        h = g * u
        return torch.einsum("bsf,fd->bsd", h, w_down)

    x = A_x
    h = x + _A_ref(_layernorm(x, axis=-1), A_wqkv, A_wo)
    h2 = h + _B_ref(_layernorm(h, axis=-1), B_w_gate, B_w_up, B_w_down)
    return h2
```

```asm
; @launch grid=(256,1,1) block=(512,1,1) lds=163840
.amdgcn_target "amdgcn-amd-amdhsa--gfx950"
.text
.globl sequential_preLN__sliding_block__glu_gated_bilinear__prompt_kernel
.p2align 8
.type sequential_preLN__sliding_block__glu_gated_bilinear__prompt_kernel,@function
sequential_preLN__sliding_block__glu_gated_bilinear__prompt_kernel:
    s_load_dwordx2 s[8:9], s[0:1], 0
    s_load_dwordx2 s[12:13], s[0:1], 8
    s_load_dwordx2 s[36:37], s[0:1], 72
    s_load_dwordx2 s[16:17], s[0:1], 16
    s_load_dwordx2 s[40:41], s[0:1], 64
    s_load_dwordx2 s[20:21], s[0:1], 32
    s_load_dwordx2 s[24:25], s[0:1], 40
    s_load_dwordx2 s[28:29], s[0:1], 48
    s_load_dwordx2 s[32:33], s[0:1], 56
    s_cmp_ge_u32 s2, 256
    s_cbranch_scc1 L_end
    v_lshrrev_b32 v2, 6, v0
    v_and_b32 v1, 63, v0
    v_readfirstlane_b32 s44, v2
    s_lshr_b32 s47, s2, 3
    s_cmp_eq_u32 s44, 3
    s_cbranch_scc0 Lncp_1
    s_getpc_b64 s[4:5]
Lpc_2:
    s_sub_u32 s4, s4, Lpc_2-sequential_preLN__sliding_block__glu_gated_bilinear__prompt_kernel
    s_subb_u32 s5, s5, 0
    v_lshlrev_b32 v2, 7, v1
    s_mul_i32 s3, s47, 1280
    s_add_u32 s3, s3, sequential_preLN__sliding_block__glu_gated_bilinear__prompt_kernel-sequential_preLN__sliding_block__glu_gated_bilinear__prompt_kernel
    v_add_u32 v2, s3, v2
    v_min_u32 v2, 40832, v2
    s_mov_b64 exec, 0x3ff
    global_load_dword v220, v2, s[4:5]
    s_mov_b64 exec, -1
Lncp_1:
    s_mov_b32 s10, 2621440
    s_mov_b32 s11, 0x20000
    s_mov_b32 s14, 2457600
    s_mov_b32 s15, 0x20000
    s_mov_b32 s38, 33554432
    s_mov_b32 s39, 0x20000
    s_mov_b32 s42, 256
    s_mov_b32 s43, 0x20000
    s_mov_b32 s18, 819200
    s_mov_b32 s19, 0x20000
    s_mov_b32 s22, 1966080
    s_mov_b32 s23, 0x20000
    s_mov_b32 s26, 1966080
    s_mov_b32 s27, 0x20000
    s_mov_b32 s30, 1966080
    s_mov_b32 s31, 0x20000
    s_mov_b32 s34, 2621440
    s_mov_b32 s35, 0x20000
    s_bfe_u32 s45, s2, 0x20001
    s_and_b32 s46, s2, 1
    s_lshr_b32 s47, s2, 3
    s_and_b32 s3, s47, 3
    s_lshl_b32 s48, s45, 2
    s_add_u32 s48, s48, s3
    s_lshr_b32 s3, s47, 2
    s_lshl_b32 s49, s46, 3
    s_add_u32 s49, s49, s3
    s_and_b32 s57, s44, 3
    v_mov_b32 v152, -1
    v_mov_b32 v154, -1
    v_mov_b32 v156, -1
    v_mov_b32 v158, -1
    v_mov_b32 v153, -1
    v_mov_b32 v155, -1
    v_mov_b32 v157, -1
    v_mov_b32 v159, -1
    v_mov_b32 v23, -1
    v_mov_b32 v24, -1
    s_lshl_b32 s56, s46, 5
    s_add_u32 s56, s56, s47
    s_lshl_b32 s56, s56, 3
    s_lshl_b32 s3, s45, 9
    s_add_u32 s56, s56, s3
    s_lshr_b32 s64, s56, 7
    s_cmp_ge_u32 s44, 2
    s_cbranch_scc1 L_e1
    s_lshl_b32 s3, s44, 2
    s_add_u32 s56, s56, s3
    v_lshrrev_b32 v2, 4, v1
    v_and_b32 v3, 15, v1
    v_mul_u32_u24 v4, 1280, v2
    v_lshl_add_u32 v4, v3, 4, v4
    s_lshl_b32 s55, s56, 3
    s_add_u32 s55, s55, 65536
    s_mul_i32 s54, s56, 1280
    s_waitcnt lgkmcnt(0)
    buffer_load_dwordx4 v[32:35], v4, s[8:11], s54 offen offset:0
    buffer_load_dwordx4 v[36:39], v4, s[8:11], s54 offen offset:256
    buffer_load_dwordx4 v[40:43], v4, s[8:11], s54 offen offset:512
    buffer_load_dwordx4 v[44:47], v4, s[8:11], s54 offen offset:768
    buffer_load_dwordx4 v[48:51], v4, s[8:11], s54 offen offset:1024
L_e1:
    s_cmp_lt_u32 s44, 4
    s_cbranch_scc1 L_p1_comp
L_p1_loader:
    s_and_b32 s3, s2, 0xfd
    s_cmp_lg_u32 s3, 225
    s_cbranch_scc1 L_noinit
    v_mov_b32 v4, 0
    v_mov_b32 v5, 0
    v_mov_b32 v6, 0
    v_mov_b32 v7, 0
    v_lshlrev_b32 v2, 4, v1
    s_lshl_b32 s3, s57, 13
    s_lshl_b32 s4, s45, 15
    s_add_u32 s3, s3, s4
    s_add_u32 s4, s3, 4096
    s_waitcnt lgkmcnt(0)
    buffer_store_dwordx4 v[4:7], v2, s[36:39], s3 offen offset:0 sc1
    buffer_store_dwordx4 v[4:7], v2, s[36:39], s3 offen offset:1024 sc1
    buffer_store_dwordx4 v[4:7], v2, s[36:39], s3 offen offset:2048 sc1
    buffer_store_dwordx4 v[4:7], v2, s[36:39], s3 offen offset:3072 sc1
    buffer_store_dwordx4 v[4:7], v2, s[36:39], s4 offen offset:0 sc1
    buffer_store_dwordx4 v[4:7], v2, s[36:39], s4 offen offset:1024 sc1
    buffer_store_dwordx4 v[4:7], v2, s[36:39], s4 offen offset:2048 sc1
    buffer_store_dwordx4 v[4:7], v2, s[36:39], s4 offen offset:3072 sc1
    v_mov_b32 v3, 1
    s_waitcnt vmcnt(0)
    s_mov_b64 exec, 1
    buffer_atomic_add v3, off, s[40:43], 0 sc1
    s_mov_b64 exec, -1
L_noinit:
    v_lshrrev_b32 v2, 3, v1
    v_lshrrev_b32 v3, 4, v1
    s_lshl_b32 s3, s57, 2
    v_add_u32 v4, s3, v3
    v_and_b32 v4, 7, v4
    v_and_b32 v5, 7, v1
    v_xor_b32 v4, v4, v5
    v_mul_u32_u24 v2, 2560, v2
    v_lshl_add_u32 v8, v4, 4, v2
    s_lshl_b32 s4, s48, 7
    s_and_b32 s5, s57, 1
    s_lshl_b32 s5, s5, 4
    s_add_u32 s4, s4, s5
    s_lshr_b32 s5, s57, 1
    s_add_u32 s4, s4, s5
    s_mul_i32 s58, s4, 1280
    v_lshlrev_b32 v4, 2, v3
    s_lshl_b32 s5, s5, 1
    v_add_u32 v4, s5, v4
    v_and_b32 v5, 15, v1
    v_xor_b32 v4, v4, v5
    v_mul_u32_u24 v2, 3840, v3
    v_lshl_add_u32 v9, v4, 4, v2
    s_mul_i32 s59, s3, 3840
    s_lshl_b32 s4, s49, 8
    s_add_u32 s59, s59, s4
    s_lshl_b32 s60, s57, 10
    s_mov_b32 s61, 0
    s_lshr_b32 s62, s47, 2
    s_and_b32 s3, s47, 3
    s_mul_i32 s3, s3, 5
    s_add_u32 s3, s3, s45
    s_lshr_b32 s3, s3, 1
    s_add_u32 s62, s62, s3
    s_cmp_ge_u32 s62, 10
    s_cselect_b32 s3, 10, 0
    s_sub_u32 s62, s62, s3
    s_mul_i32 s62, s62, 1
    s_lshl_b32 s3, s62, 7
    s_add_u32 s58, s58, s3
    s_mul_i32 s3, s62, 245760
    s_add_u32 s59, s59, s3
    s_waitcnt lgkmcnt(0)
    s_cmp_eq_u32 s49, 15
    s_cbranch_scc1 L_idle
L_p1_pro:
    s_add_u32 m0, s60, 0
    s_add_u32 s3, s58, 0
    buffer_load_dwordx4 v8, s[8:11], s3 offen lds
    s_add_u32 m0, s60, 16384
    s_add_u32 s3, s59, 0
    buffer_load_dwordx4 v9, s[12:15], s3 offen lds
    s_add_u32 m0, s60, 4096
    s_add_u32 s3, s58, 40960
    buffer_load_dwordx4 v8, s[8:11], s3 offen lds
    s_add_u32 m0, s60, 20480
    s_add_u32 s3, s59, 61440
    buffer_load_dwordx4 v9, s[12:15], s3 offen lds
    s_add_u32 m0, s60, 8192
    s_add_u32 s3, s58, 81920
    buffer_load_dwordx4 v8, s[8:11], s3 offen lds
    s_add_u32 m0, s60, 24576
    s_add_u32 s3, s59, 122880
    buffer_load_dwordx4 v9, s[12:15], s3 offen lds
    s_add_u32 m0, s60, 12288
    s_add_u32 s3, s58, 122880
    buffer_load_dwordx4 v8, s[8:11], s3 offen lds
    s_add_u32 m0, s60, 28672
    s_add_u32 s3, s59, 184320
    buffer_load_dwordx4 v9, s[12:15], s3 offen lds
    s_add_u32 s58, s58, 128
    s_add_u32 s59, s59, 245760
    s_add_u32 s60, s60, 32768
    s_and_b32 s60, s60, 0x1ffff
    s_add_u32 s62, s62, 1
    s_cmp_eq_u32 s62, 10
    s_cselect_b32 s3, 1280, 0
    s_sub_u32 s58, s58, s3
    s_cmp_eq_u32 s62, 10
    s_cselect_b32 s3, 2457600, 0
    s_sub_u32 s59, s59, s3
    s_add_u32 s61, s61, 1
    s_cmp_eq_u32 s61, 1
    s_cbranch_scc1 L_p1_pro
    s_cmp_eq_u32 s61, 2
    s_cbranch_scc0 L_p1_l2
    v_and_b32 v23, 7, v1
    v_lshlrev_b32 v23, 12, v23
    v_bfe_u32 v2, v1, 3, 1
    v_lshl_add_u32 v23, v2, 7, v23
    s_and_b32 s3, s64, 3
    s_lshl_b32 s3, s3, 10
    s_lshr_b32 s4, s64, 2
    s_lshl_b32 s4, s4, 8
    s_add_u32 s3, s3, s4
    s_add_u32 s3, s3, 0
    v_add_u32 v23, s3, v23
    v_lshlrev_b32 v24, 4, v1
    s_lshl_b32 s63, s2, 7
L_p1_l2:
    s_waitcnt vmcnt(8)
    s_cmp_eq_u32 s44, 4
    s_cbranch_scc0 L_p1_l3
    s_cmp_eq_u32 s61, 6
    s_cbranch_scc0 L_p1_l4
    s_mov_b32 s3, 0
Lip_3:
    v_readfirstlane_b32 s4, v22
    s_add_u32 s3, s3, 1
    s_cmp_gt_u32 s3, 262144
    s_cselect_b32 s4, 8, s4
    s_cmp_ge_u32 s4, 8
    s_cbranch_scc1 Lip_3x
    buffer_load_dword v22, off, s[40:43], 0 sc1
    s_waitcnt vmcnt(0)
    s_branch Lip_3
Lip_3x:
    v_mov_b32 v21, 2
    s_mov_b64 exec, 0xffff
    buffer_atomic_add v21, v23, s[36:39], 0 offen sc1
    s_mov_b64 exec, -1
L_p1_l4:
    s_cmp_eq_u32 s61, 10
    s_cbranch_scc0 L_p1_l3
    s_mov_b32 s3, 0
Lsp_4:
    v_readfirstlane_b32 s4, v22
    s_add_u32 s3, s3, 1
    s_cmp_gt_u32 s3, 262144
    s_cselect_b32 s4, 32, s4
    s_cmp_ge_u32 s4, 32
    s_cbranch_scc1 Lsp_4x
    buffer_load_dword v22, off, s[36:39], s63 sc1
    s_waitcnt vmcnt(0)
    s_branch Lsp_4
Lsp_4x:
    s_mov_b32 m0, 137216
    s_lshl_b32 s3, s48, 10
    s_add_u32 s3, s3, 65536
    buffer_load_dwordx4 v24, s[36:39], s3 offen sc1 lds
L_p1_l3:
    s_barrier
    s_cmp_eq_u32 s61, 10
    s_cbranch_scc1 L_p1_lt
    s_cmp_eq_u32 s61, 5
    s_cbranch_scc0 L_p1_l5
    buffer_load_dword v22, off, s[40:43], 0 sc1
L_p1_l5:
    s_cmp_eq_u32 s61, 9
    s_cbranch_scc0 L_p1_pro
    buffer_load_dword v22, off, s[36:39], s63 sc1
    s_branch L_p1_pro
L_p1_lt:
    v_lshlrev_b32 v2, 4, v1
    s_lshl_b32 s3, s57, 11
    s_add_u32 s3, s3, 139264
    v_add_u32 v2, s3, v2
    ds_read_b128 v[152:155], v2
    ds_read_b128 v[156:159], v2 offset:1024
    s_waitcnt lgkmcnt(0)
    buffer_load_dwordx4 v[128:131], v152, s[20:23], 0 offen
    buffer_load_dwordx4 v[132:135], v152, s[24:27], 0 offen
    buffer_load_dwordx4 v[140:143], v156, s[20:23], 0 offen
    buffer_load_dwordx4 v[144:147], v156, s[24:27], 0 offen
    s_cmp_eq_u32 s49, 15
    s_cbranch_scc1 L_rt12
    s_waitcnt vmcnt(4)
    s_barrier
    s_barrier
L_rt12:
    s_barrier
    v_mul_u32_u24 v4, 26, v1
    v_lshrrev_b32 v4, 8, v4
    v_mul_u32_u24 v5, 10, v4
    v_sub_u32 v5, v1, v5
    v_mul_u32_u24 v12, 1280, v4
    v_lshl_add_u32 v12, v5, 4, v12
    s_lshr_b32 s3, s47, 3
    s_lshl_b32 s4, s46, 2
    s_add_u32 s3, s3, s4
    s_mul_i32 s5, s3, 160
    s_mul_i32 s59, s57, 204800
    s_add_u32 s59, s59, s5
    s_mul_i32 s60, s57, 25600
    s_add_u32 s60, s60, 55296
    s_mov_b32 s3, 0
L_wopre:
    s_add_u32 m0, s60, 0
    s_add_u32 s4, s59, 0
    buffer_load_dwordx4 v12, s[16:19], s4 offen lds
    s_add_u32 m0, s60, 12800
    s_add_u32 s4, s59, 102400
    buffer_load_dwordx4 v12, s[16:19], s4 offen lds
    s_add_u32 s60, s60, 960
    s_add_u32 s59, s59, 7680
    s_add_u32 s3, s3, 1
    s_cmp_lt_u32 s3, 9
    s_cbranch_scc1 L_wopre
    s_branch L_p2
L_p1_comp:
    s_waitcnt lgkmcnt(0)
    v_lshlrev_b32 v2, 2, v1
    v_add_u32 v2, 163776, v2
    v_mov_b32 v3, 0
    s_mov_b64 exec, 0xffff
    ds_write_b32 v2, v3
    s_mov_b64 exec, -1
    s_lshl_b32 s65, s44, 1
    s_add_u32 s66, s65, 2
    s_and_b32 s3, s47, 7
    s_lshl_b32 s52, s45, 3
    s_add_u32 s52, s52, s3
    s_lshr_b32 s3, s47, 3
    s_lshl_b32 s53, s46, 2
    s_add_u32 s53, s53, s3
    s_lshr_b32 s94, s52, 1
    s_lshl_b32 s95, s53, 1
    s_and_b32 s3, s47, 1
    s_add_u32 s95, s95, s3
L_rtl:
    v_lshrrev_b32 v2, 3, v1
    s_lshl_b32 s3, s65, 3
    v_add_u32 v2, s3, v2
    v_bfe_u32 v3, v1, 1, 2
    v_and_b32 v4, 1, v1
    v_lshlrev_b32 v4, 4, v4
    v_lshl_add_u32 v5, v3, 5, v4
    v_cmp_lt_u32 vcc, 59, v2
    v_mov_b32 v6, 0
    v_mov_b32 v7, 1073741824
    v_cndmask_b32 v6, v6, v7, vcc
    v_mul_u32_u24 v7, 43, v2
    v_lshrrev_b32 v7, 8, v7
    v_mul_u32_u24 v18, 6, v7
    v_sub_u32 v18, v2, v18
    s_mul_i32 s3, s94, 40
    v_lshl_add_u32 v19, v7, 2, v3
    v_add_u32 v19, s3, v19
    v_mul_u32_u24 v19, 3072, v19
    v_lshl_add_u32 v19, v18, 5, v19
    v_add_u32 v19, v19, v4
    s_mul_i32 s3, s95, 192
    v_add_u32 v19, s3, v19
    v_add_u32 v28, v19, v6
    s_and_b32 s3, s94, 1
    s_mul_i32 s3, s3, 10
    v_add_u32 v7, s3, v7
    s_lshr_b32 s4, s94, 1
    s_lshl_b32 s5, s4, 2
    s_mov_b32 s6, 32768
    v_lshrrev_b32 v19, 2, v7
    v_add_u32 v20, s5, v19
    s_and_b32 s7, s4, 1
    s_lshl_b32 s7, s7, 1
    s_and_b32 s4, s4, 6
    s_add_u32 s4, s4, 32
    v_and_b32 v21, 1, v7
    v_add_u32 v21, s4, v21
    v_bfe_u32 v27, v7, 1, 1
    v_add_u32 v27, s7, v27
    v_cmp_eq_u32 vcc, 4, v19
    s_nop 1
    v_cndmask_b32 v20, v20, v21, vcc
    v_and_b32 v7, 3, v7
    v_cndmask_b32 v7, v7, v27, vcc
    v_lshrrev_b32 v19, 1, v20
    v_lshlrev_b32 v21, 13, v19
    v_lshl_add_u32 v21, v18, 11, v21
    v_cmp_lt_u32 vcc, 7, v19
    v_lshlrev_b32 v19, 12, v19
    v_and_b32 v25, 1, v18
    v_lshl_add_u32 v19, v25, 11, v19
    v_lshrrev_b32 v25, 1, v18
    v_mul_u32_u24 v26, 49152, v25
    v_add3_u32 v26, v26, v19, s6
    v_cndmask_b32 v21, v21, v26, vcc
    v_add_u32 v19, 163840, v19
    v_cmp_lt_u32 vcc, 3, v18
    s_nop 1
    v_cndmask_b32 v21, v21, v19, vcc
    v_and_b32 v19, 1, v20
    v_lshl_add_u32 v21, v19, 9, v21
    v_and_b32 v19, 3, v7
    v_lshl_add_u32 v21, v19, 7, v21
    v_add_u32 v21, v21, v5
    s_mul_i32 s3, s95, 245760
    s_add_u32 s3, s3, 25165824
    v_add_u32 v21, s3, v21
    v_add_u32 v29, v21, v6
    v_mul_u32_u24 v7, 52, v2
    v_lshrrev_b32 v7, 8, v7
    v_mul_u32_u24 v18, 5, v7
    v_sub_u32 v18, v2, v18
    s_mul_i32 s3, s52, 48
    v_lshl_add_u32 v19, v7, 2, v3
    v_add_u32 v19, s3, v19
    v_mul_u32_u24 v19, 1280, v19
    v_lshl_add_u32 v19, v18, 5, v19
    v_add_u32 v19, v19, v4
    s_mul_i32 s3, s53, 160
    v_add_u32 v19, s3, v19
    v_add_u32 v30, v19, v6
    s_and_b32 s3, s52, 1
    s_mul_i32 s3, s3, 3
    v_lshrrev_b32 v19, 2, v7
    v_add_u32 v19, s3, v19
    s_lshr_b32 s4, s52, 1
    v_lshrrev_b32 v20, 1, v19
    v_lshlrev_b32 v20, 4, v20
    v_add_u32 v20, s4, v20
    v_mul_u32_u24 v20, 5, v20
    v_add_u32 v20, v20, v18
    v_lshlrev_b32 v20, 10, v20
    v_and_b32 v19, 1, v19
    v_lshl_add_u32 v20, v19, 9, v20
    v_and_b32 v19, 3, v7
    v_lshl_add_u32 v20, v19, 7, v20
    v_add_u32 v20, v20, v5
    s_mul_i32 s3, s53, 245760
    s_add_u32 s3, s3, 29360128
    v_add_u32 v20, s3, v20
    v_add_u32 v31, v20, v6
    v_lshlrev_b32 v2, 4, v1
    s_lshl_b32 s3, s65, 10
    s_add_u32 s3, s3, 139264
    v_add_u32 v2, s3, v2
    ds_write_b128 v2, v[28:31]
    s_add_u32 s65, s65, 1
    s_cmp_lt_u32 s65, s66
    s_cbranch_scc1 L_rtl
    s_cmp_ge_u32 s44, 2
    s_cbranch_scc1 L_rowdone
    v_lshrrev_b32 v2, 4, v1
    v_and_b32 v3, 15, v1
    v_mov_b32 v5, 0
    v_mov_b32 v6, 0
    v_mov_b32 v7, 0x3f803f80
    s_waitcnt vmcnt(0)
    v_dot2c_f32_bf16 v5, v32, v7
    v_dot2c_f32_bf16 v5, v33, v7
    v_dot2c_f32_bf16 v5, v34, v7
    v_dot2c_f32_bf16 v5, v35, v7
    v_dot2c_f32_bf16 v5, v36, v7
    v_dot2c_f32_bf16 v5, v37, v7
    v_dot2c_f32_bf16 v5, v38, v7
    v_dot2c_f32_bf16 v5, v39, v7
    v_dot2c_f32_bf16 v5, v40, v7
    v_dot2c_f32_bf16 v5, v41, v7
    v_dot2c_f32_bf16 v5, v42, v7
    v_dot2c_f32_bf16 v5, v43, v7
    v_dot2c_f32_bf16 v5, v44, v7
    v_dot2c_f32_bf16 v5, v45, v7
    v_dot2c_f32_bf16 v5, v46, v7
    v_dot2c_f32_bf16 v5, v47, v7
    v_dot2c_f32_bf16 v5, v48, v7
    v_dot2c_f32_bf16 v5, v49, v7
    v_dot2c_f32_bf16 v5, v50, v7
    v_dot2c_f32_bf16 v5, v51, v7
    v_dot2c_f32_bf16 v6, v32, v32
    v_dot2c_f32_bf16 v6, v33, v33
    v_dot2c_f32_bf16 v6, v34, v34
    v_dot2c_f32_bf16 v6, v35, v35
    v_dot2c_f32_bf16 v6, v36, v36
    v_dot2c_f32_bf16 v6, v37, v37
    v_dot2c_f32_bf16 v6, v38, v38
    v_dot2c_f32_bf16 v6, v39, v39
    v_dot2c_f32_bf16 v6, v40, v40
    v_dot2c_f32_bf16 v6, v41, v41
    v_dot2c_f32_bf16 v6, v42, v42
    v_dot2c_f32_bf16 v6, v43, v43
    v_dot2c_f32_bf16 v6, v44, v44
    v_dot2c_f32_bf16 v6, v45, v45
    v_dot2c_f32_bf16 v6, v46, v46
    v_dot2c_f32_bf16 v6, v47, v47
    v_dot2c_f32_bf16 v6, v48, v48
    v_dot2c_f32_bf16 v6, v49, v49
    v_dot2c_f32_bf16 v6, v50, v50
    v_dot2c_f32_bf16 v6, v51, v51
    v_add_f32_dpp v5, v5, v5 row_ror:8 row_mask:0xf bank_mask:0xf
    s_nop 1
    v_add_f32_dpp v6, v6, v6 row_ror:8 row_mask:0xf bank_mask:0xf
    v_add_f32_dpp v5, v5, v5 row_ror:4 row_mask:0xf bank_mask:0xf
    s_nop 0
    v_add_f32_dpp v6, v6, v6 row_ror:4 row_mask:0xf bank_mask:0xf
    v_add_f32_dpp v5, v5, v5 row_ror:2 row_mask:0xf bank_mask:0xf
    s_nop 0
    v_add_f32_dpp v6, v6, v6 row_ror:2 row_mask:0xf bank_mask:0xf
    v_add_f32_dpp v5, v5, v5 row_ror:1 row_mask:0xf bank_mask:0xf
    s_nop 0
    v_add_f32_dpp v6, v6, v6 row_ror:1 row_mask:0xf bank_mask:0xf
    v_mul_f32 v5, 0xbacccccd, v5
    v_mul_f32 v6, 0x3acccccd, v6
    v_fma_f32 v6, -v5, v5, v6
    v_max_f32 v6, 0, v6
    v_add_f32 v6, 0x3727c5ac, v6
    v_rsq_f32 v9, v6
    v_cvt_pk_bf16_f32 v8, v5, v5
    v_and_b32 v8, 0xffff0000, v8
    v_sub_f32 v5, v5, v8
    v_cvt_pk_bf16_f32 v8, v8, v5
    v_lshlrev_b32 v2, 3, v2
    v_cmp_eq_u32 vcc, 0, v3
    s_nop 0
    s_and_saveexec_b64 s[4:5], vcc
    buffer_store_dwordx2 v[8:9], v2, s[36:39], s55 offen sc1
    s_mov_b64 exec, -1
L_rowdone:
    s_cmp_eq_u32 s49, 15
    s_cbranch_scc1 L_idle
    v_lshrrev_b32 v2, 4, v1
    v_and_b32 v3, 15, v1
    s_and_b32 s57, s44, 1
    s_lshr_b32 s58, s44, 1
    s_lshl_b32 s3, s57, 13
    v_lshlrev_b32 v4, 7, v3
    v_add_u32 v4, s3, v4
    v_lshrrev_b32 v5, 1, v3
    v_xor_b32 v5, v5, v2
    v_lshl_add_u32 v8, v5, 4, v4
    v_xor_b32 v5, 4, v5
    v_lshl_add_u32 v9, v5, 4, v4
    v_bfe_u32 v4, v1, 2, 2
    v_lshl_add_u32 v5, v2, 3, v4
    v_lshlrev_b32 v5, 8, v5
    v_and_b32 v6, 3, v1
    v_lshl_add_u32 v5, v6, 3, v5
    v_add_u32 v5, 16384, v5
    v_and_b32 v6, 1, v2
    v_lshl_add_u32 v6, v4, 1, v6
    s_lshl_b32 s3, s58, 2
    s_lshl_b32 s4, s57, 1
    s_add_u32 s3, s3, s4
    v_xor_b32 v6, s3, v6
    v_xor_b32 v7, 0, v6
    v_lshl_add_u32 v10, v7, 5, v5
    v_xor_b32 v7, 1, v6
    v_lshl_add_u32 v11, v7, 5, v5
    v_xor_b32 v7, 2, v6
    v_lshl_add_u32 v12, v7, 5, v5
    v_xor_b32 v7, 3, v6
    v_lshl_add_u32 v13, v7, 5, v5
    v_mov_b32 v14, v8
    v_mov_b32 v15, v9
    v_mov_b32 v16, v10
    v_mov_b32 v17, v11
    v_mov_b32 v18, v12
    v_mov_b32 v19, v13
    v_mov_b32 v64, 0
    v_mov_b32 v65, 0
    v_mov_b32 v66, 0
    v_mov_b32 v67, 0
    v_mov_b32 v68, 0
    v_mov_b32 v69, 0
    v_mov_b32 v70, 0
    v_mov_b32 v71, 0
    v_mov_b32 v72, 0
    v_mov_b32 v73, 0
    v_mov_b32 v74, 0
    v_mov_b32 v75, 0
    v_mov_b32 v76, 0
    v_mov_b32 v77, 0
    v_mov_b32 v78, 0
    v_mov_b32 v79, 0
    v_mov_b32 v80, 0
    v_mov_b32 v81, 0
    v_mov_b32 v82, 0
    v_mov_b32 v83, 0
    v_mov_b32 v84, 0
    v_mov_b32 v85, 0
    v_mov_b32 v86, 0
    v_mov_b32 v87, 0
    v_mov_b32 v88, 0
    v_mov_b32 v89, 0
    v_mov_b32 v90, 0
    v_mov_b32 v91, 0
    v_mov_b32 v92, 0
    v_mov_b32 v93, 0
    v_mov_b32 v94, 0
    v_mov_b32 v95, 0
    v_mov_b32 v96, 0
    v_mov_b32 v97, 0
    v_mov_b32 v98, 0
    v_mov_b32 v99, 0
    v_mov_b32 v100, 0
    v_mov_b32 v101, 0
    v_mov_b32 v102, 0
    v_mov_b32 v103, 0
    v_mov_b32 v104, 0
    v_mov_b32 v105, 0
    v_mov_b32 v106, 0
    v_mov_b32 v107, 0
    v_mov_b32 v108, 0
    v_mov_b32 v109, 0
    v_mov_b32 v110, 0
    v_mov_b32 v111, 0
    v_mov_b32 v112, 0
    v_mov_b32 v113, 0
    v_mov_b32 v114, 0
    v_mov_b32 v115, 0
    v_mov_b32 v116, 0
    v_mov_b32 v117, 0
    v_mov_b32 v118, 0
    v_mov_b32 v119, 0
    v_mov_b32 v120, 0
    v_mov_b32 v121, 0
    v_mov_b32 v122, 0
    v_mov_b32 v123, 0
    v_mov_b32 v124, 0
    v_mov_b32 v125, 0
    v_mov_b32 v126, 0
    v_mov_b32 v127, 0
    v_mov_b32 v32, 0
    v_mov_b32 v33, 0
    v_mov_b32 v34, 0
    v_mov_b32 v35, 0
    v_mov_b32 v36, 0
    v_mov_b32 v37, 0
    v_mov_b32 v38, 0
    v_mov_b32 v39, 0
    v_mov_b32 v40, 0x3f803f80
    v_mov_b32 v41, 0x3f803f80
    v_mov_b32 v42, 0x3f803f80
    v_mov_b32 v43, 0x3f803f80
    s_cmp_ge_u32 s49, 5
    s_cselect_b32 s3, 5, 0
    s_sub_u32 s4, s49, s3
    s_cmp_ge_u32 s4, 5
    s_cselect_b32 s3, 5, 0
    s_sub_u32 s4, s4, s3
    s_lshl_b32 s4, s4, 5
    s_mul_i32 s5, s4, 205
    s_lshr_b32 s5, s5, 10
    s_add_u32 s4, s4, 31
    s_mul_i32 s6, s4, 205
    s_lshr_b32 s6, s6, 10
    v_and_b32 v4, 7, v1
    v_add_u32 v4, s5, v4
    v_bfe_u32 v5, v1, 3, 1
    s_lshr_b32 s7, s48, 1
    v_add_u32 v6, s7, v5
    v_and_b32 v7, 3, v4
    v_lshlrev_b32 v44, 10, v7
    v_lshrrev_b32 v7, 2, v4
    v_lshl_add_u32 v44, v7, 7, v44
    v_lshl_add_u32 v44, v6, 12, v44
    v_add_u32 v44, 4, v44
    s_cmp_lt_u32 s49, 5
    s_cselect_b32 s7, s7, 7
    v_mov_b32 v7, 1073741824
    v_cmp_lt_u32 vcc, s6, v4
    s_nop 1
    v_cndmask_b32 v44, v44, v7, vcc
    v_cmp_lt_u32 vcc, s7, v6
    s_nop 1
    v_cndmask_b32 v44, v44, v7, vcc
    s_mov_b32 s59, 0
    s_mov_b32 s60, 0
    v_and_b32 v3, 15, v1
    v_lshlrev_b32 v46, 4, v3
    s_lshl_b32 s4, s57, 9
    s_add_u32 s4, s4, 137216
    v_add_u32 v46, s4, v46
    v_lshrrev_b32 v2, 4, v1
    v_lshlrev_b32 v2, 14, v2
    v_lshl_add_u32 v45, v3, 4, v2
    v_lshlrev_b32 v47, 4, v1
    s_lshl_b32 s3, s44, 10
    s_add_u32 s3, s3, 131072
    v_add_u32 v47, s3, v47
    s_lshl_b32 s3, s49, 19
    s_lshl_b32 s4, s58, 18
    s_add_u32 s3, s3, s4
    s_lshl_b32 s4, s48, 10
    s_add_u32 s3, s3, s4
    s_lshl_b32 s4, s57, 9
    s_add_u32 s3, s3, s4
    s_add_u32 s3, s3, 1048576
    s_lshl_b32 s4, s57, 17
    s_xor_b32 s5, s4, 131072
    s_add_u32 s66, s4, s3
    s_add_u32 s67, s5, s3
    s_add_u32 s68, s66, 65536
    s_add_u32 s69, s67, 65536
    s_cmp_lt_u32 s49, 5
    s_cselect_b32 s70, 0x3ea52b5c, 1.0
    v_cmp_gt_u32 vcc, 16, v1
    s_waitcnt lgkmcnt(0)
    s_barrier
    ds_read_b128 v[128:131], v14 offset:0
    ds_read_b64_tr_b16 v[144:145], v16 offset:0
    ds_read_b64_tr_b16 v[146:147], v16 offset:1024
    ds_read_b128 v[132:135], v14 offset:2048
    ds_read_b128 v[136:139], v14 offset:4096
    ds_read_b128 v[140:143], v14 offset:6144
    ds_read_b64_tr_b16 v[148:149], v17 offset:0
    ds_read_b64_tr_b16 v[150:151], v17 offset:1024
    ds_read_b64_tr_b16 v[152:153], v18 offset:0
    ds_read_b64_tr_b16 v[154:155], v18 offset:1024
    ds_read_b64_tr_b16 v[156:157], v19 offset:0
    ds_read_b64_tr_b16 v[158:159], v19 offset:1024
L_p1_loop:
    s_waitcnt lgkmcnt(9)
    v_mfma_f32_16x16x32_bf16 v[64:67], v[144:147], v[128:131], v[64:67]
    ds_read_b128 v[160:163], v15 offset:0
    s_add_u32 s60, s60, 32768
    s_waitcnt lgkmcnt(9)
    v_mfma_f32_16x16x32_bf16 v[68:71], v[144:147], v[132:135], v[68:71]
    ds_read_b64_tr_b16 v[176:177], v16 offset:8192
    s_and_b32 s60, s60, 0x1ffff
    s_waitcnt lgkmcnt(9)
    v_mfma_f32_16x16x32_bf16 v[72:75], v[144:147], v[136:139], v[72:75]
    ds_read_b64_tr_b16 v[178:179], v16 offset:9216
    s_add_u32 s59, s59, 1
    s_waitcnt lgkmcnt(9)
    v_mfma_f32_16x16x32_bf16 v[76:79], v[144:147], v[140:143], v[76:79]
    ds_read_b128 v[164:167], v15 offset:2048
    s_cmp_lg_u32 s59, 9
    v_mfma_f32_16x16x32_bf16 v[32:35], v[40:43], v[144:147], v[32:35]
    s_waitcnt lgkmcnt(8)
    v_mfma_f32_16x16x32_bf16 v[80:83], v[148:151], v[128:131], v[80:83]
    ds_read_b128 v[168:171], v15 offset:4096
    v_mfma_f32_16x16x32_bf16 v[84:87], v[148:151], v[132:135], v[84:87]
    ds_read_b128 v[172:175], v15 offset:6144
    v_mfma_f32_16x16x32_bf16 v[88:91], v[148:151], v[136:139], v[88:91]
    ds_read_b64_tr_b16 v[180:181], v17 offset:8192
    v_mfma_f32_16x16x32_bf16 v[92:95], v[148:151], v[140:143], v[92:95]
    ds_read_b64_tr_b16 v[182:183], v17 offset:9216
    v_mfma_f32_16x16x32_bf16 v[36:39], v[40:43], v[148:151], v[36:39]
    s_waitcnt lgkmcnt(10)
    v_mfma_f32_16x16x32_bf16 v[96:99], v[152:155], v[128:131], v[96:99]
    ds_read_b64_tr_b16 v[184:185], v18 offset:8192
    v_mfma_f32_16x16x32_bf16 v[100:103], v[152:155], v[132:135], v[100:103]
    ds_read_b64_tr_b16 v[186:187], v18 offset:9216
    v_mfma_f32_16x16x32_bf16 v[104:107], v[152:155], v[136:139], v[104:107]
    ds_read_b64_tr_b16 v[188:189], v19 offset:8192
    v_mfma_f32_16x16x32_bf16 v[108:111], v[152:155], v[140:143], v[108:111]
    ds_read_b64_tr_b16 v[190:191], v19 offset:9216
    s_waitcnt lgkmcnt(12)
    v_mfma_f32_16x16x32_bf16 v[112:115], v[156:159], v[128:131], v[112:115]
    v_add_u32 v14, s60, v8
    v_add_u32 v15, s60, v9
    v_mfma_f32_16x16x32_bf16 v[116:119], v[156:159], v[132:135], v[116:119]
    v_add_u32 v16, s60, v10
    v_add_u32 v17, s60, v11
    v_mfma_f32_16x16x32_bf16 v[120:123], v[156:159], v[136:139], v[120:123]
    v_add_u32 v18, s60, v12
    v_add_u32 v19, s60, v13
    v_mfma_f32_16x16x32_bf16 v[124:127], v[156:159], v[140:143], v[124:127]
    s_waitcnt lgkmcnt(9)
    v_mfma_f32_16x16x32_bf16 v[64:67], v[176:179], v[160:163], v[64:67]
    s_waitcnt vmcnt(0) lgkmcnt(0)
    s_barrier
    ds_read_b128 v[128:131], v14 offset:0
    v_mfma_f32_16x16x32_bf16 v[68:71], v[176:179], v[164:167], v[68:71]
    ds_read_b64_tr_b16 v[144:145], v16 offset:0
    v_mfma_f32_16x16x32_bf16 v[72:75], v[176:179], v[168:171], v[72:75]
    ds_read_b64_tr_b16 v[146:147], v16 offset:1024
    v_mfma_f32_16x16x32_bf16 v[76:79], v[176:179], v[172:175], v[76:79]
    ds_read_b128 v[132:135], v14 offset:2048
    v_mfma_f32_16x16x32_bf16 v[32:35], v[40:43], v[176:179], v[32:35]
    v_mfma_f32_16x16x32_bf16 v[80:83], v[180:183], v[160:163], v[80:83]
    ds_read_b128 v[136:139], v14 offset:4096
    v_mfma_f32_16x16x32_bf16 v[84:87], v[180:183], v[164:167], v[84:87]
    ds_read_b128 v[140:143], v14 offset:6144
    v_mfma_f32_16x16x32_bf16 v[88:91], v[180:183], v[168:171], v[88:91]
    ds_read_b64_tr_b16 v[148:149], v17 offset:0
    v_mfma_f32_16x16x32_bf16 v[92:95], v[180:183], v[172:175], v[92:95]
    ds_read_b64_tr_b16 v[150:151], v17 offset:1024
    v_mfma_f32_16x16x32_bf16 v[36:39], v[40:43], v[180:183], v[36:39]
    v_mfma_f32_16x16x32_bf16 v[96:99], v[184:187], v[160:163], v[96:99]
    ds_read_b64_tr_b16 v[152:153], v18 offset:0
    v_mfma_f32_16x16x32_bf16 v[100:103], v[184:187], v[164:167], v[100:103]
    ds_read_b64_tr_b16 v[154:155], v18 offset:1024
    v_mfma_f32_16x16x32_bf16 v[104:107], v[184:187], v[168:171], v[104:107]
    ds_read_b64_tr_b16 v[156:157], v19 offset:0
    v_mfma_f32_16x16x32_bf16 v[108:111], v[184:187], v[172:175], v[108:111]
    ds_read_b64_tr_b16 v[158:159], v19 offset:1024
    v_mfma_f32_16x16x32_bf16 v[112:115], v[188:191], v[160:163], v[112:115]
    v_mfma_f32_16x16x32_bf16 v[116:119], v[188:191], v[164:167], v[116:119]
    v_mfma_f32_16x16x32_bf16 v[120:123], v[188:191], v[168:171], v[120:123]
    v_mfma_f32_16x16x32_bf16 v[124:127], v[188:191], v[172:175], v[124:127]
    s_cbranch_scc1 L_p1_loop
    s_waitcnt lgkmcnt(4)
    v_mfma_f32_16x16x32_bf16 v[32:35], v[40:43], v[144:147], v[32:35]
    ds_read_b64_tr_b16 v[176:177], v16 offset:8192
    v_mfma_f32_16x16x32_bf16 v[36:39], v[40:43], v[148:151], v[36:39]
    ds_read_b64_tr_b16 v[178:179], v16 offset:9216
    v_mfma_f32_16x16x32_bf16 v[64:67], v[144:147], v[128:131], v[64:67]
    ds_read_b64_tr_b16 v[180:181], v17 offset:8192
    v_mfma_f32_16x16x32_bf16 v[68:71], v[144:147], v[132:135], v[68:71]
    ds_read_b64_tr_b16 v[182:183], v17 offset:9216
    v_mfma_f32_16x16x32_bf16 v[72:75], v[144:147], v[136:139], v[72:75]
    ds_read_b128 v[160:163], v15 offset:0
    v_mfma_f32_16x16x32_bf16 v[76:79], v[144:147], v[140:143], v[76:79]
    ds_read_b128 v[164:167], v15 offset:2048
    v_mfma_f32_16x16x32_bf16 v[80:83], v[148:151], v[128:131], v[80:83]
    ds_read_b128 v[168:171], v15 offset:4096
    v_mfma_f32_16x16x32_bf16 v[84:87], v[148:151], v[132:135], v[84:87]
    ds_read_b128 v[172:175], v15 offset:6144
    v_mfma_f32_16x16x32_bf16 v[88:91], v[148:151], v[136:139], v[88:91]
    ds_read_b64_tr_b16 v[184:185], v18 offset:8192
    v_mfma_f32_16x16x32_bf16 v[92:95], v[148:151], v[140:143], v[92:95]
    ds_read_b64_tr_b16 v[186:187], v18 offset:9216
    ds_read_b64_tr_b16 v[188:189], v19 offset:8192
    ds_read_b64_tr_b16 v[190:191], v19 offset:9216
    ds_read_b128 v[24:27], v46
    ds_read_b128 v[28:31], v46 offset:256
    s_waitcnt lgkmcnt(10)
    v_mfma_f32_16x16x32_bf16 v[32:35], v[40:43], v[176:179], v[32:35]
    v_mfma_f32_16x16x32_bf16 v[36:39], v[40:43], v[180:183], v[36:39]
    s_waitcnt lgkmcnt(6)
    v_mfma_f32_16x16x32_bf16 v[64:67], v[176:179], v[160:163], v[64:67]
    v_mfma_f32_16x16x32_bf16 v[68:71], v[176:179], v[164:167], v[68:71]
    v_mfma_f32_16x16x32_bf16 v[72:75], v[176:179], v[168:171], v[72:75]
    v_mfma_f32_16x16x32_bf16 v[76:79], v[176:179], v[172:175], v[76:79]
    v_mfma_f32_16x16x32_bf16 v[80:83], v[180:183], v[160:163], v[80:83]
    s_nop 0
    v_cndmask_b32 v32, 0, v32, vcc
    v_cvt_pk_bf16_f32 v48, v32, v32
    v_and_b32 v33, 0xffff0000, v48
    v_mfma_f32_16x16x32_bf16 v[84:87], v[180:183], v[164:167], v[84:87]
    v_sub_f32 v33, v32, v33
    v_cvt_pk_bf16_f32 v49, v33, v33
    v_cndmask_b32 v36, 0, v36, vcc
    v_mfma_f32_16x16x32_bf16 v[88:91], v[180:183], v[168:171], v[88:91]
    v_cvt_pk_bf16_f32 v50, v36, v36
    v_and_b32 v37, 0xffff0000, v50
    v_sub_f32 v37, v36, v37
    v_mfma_f32_16x16x32_bf16 v[92:95], v[180:183], v[172:175], v[92:95]
    v_cvt_pk_bf16_f32 v51, v37, v37
    ds_write_b128 v47, v[48:51]
    s_waitcnt lgkmcnt(1)
    v_mfma_f32_16x16x32_bf16 v[96:99], v[152:155], v[128:131], v[96:99]
    v_mov_b32 v56, v24
    v_mov_b32 v57, v24
    v_mul_f32 v25, s70, v25
    v_mfma_f32_16x16x32_bf16 v[100:103], v[152:155], v[132:135], v[100:103]
    v_mov_b32 v58, v26
    v_mov_b32 v59, v26
    v_mul_f32 v27, s70, v27
    v_mfma_f32_16x16x32_bf16 v[104:107], v[152:155], v[136:139], v[104:107]
    v_mov_b32 v60, v28
    v_mov_b32 v61, v28
    v_mul_f32 v29, s70, v29
    v_mfma_f32_16x16x32_bf16 v[108:111], v[152:155], v[140:143], v[108:111]
    v_mov_b32 v62, v30
    v_mov_b32 v63, v30
    v_mul_f32 v31, s70, v31
    v_mfma_f32_16x16x16_bf16 v[64:67], v[48:49], v[56:57], v[64:67]
    v_mfma_f32_16x16x16_bf16 v[68:71], v[48:49], v[58:59], v[68:71]
    v_mfma_f32_16x16x16_bf16 v[72:75], v[48:49], v[60:61], v[72:75]
    v_mfma_f32_16x16x16_bf16 v[76:79], v[48:49], v[62:63], v[76:79]
    s_waitcnt lgkmcnt(0)
    s_barrier
    v_xor_b32 v47, 1024, v47
    ds_read_b128 v[52:55], v47
    v_mfma_f32_16x16x16_bf16 v[80:83], v[50:51], v[56:57], v[80:83]
    v_mfma_f32_16x16x16_bf16 v[84:87], v[50:51], v[58:59], v[84:87]
    v_mfma_f32_16x16x16_bf16 v[88:91], v[50:51], v[60:61], v[88:91]
    v_mfma_f32_16x16x16_bf16 v[92:95], v[50:51], v[62:63], v[92:95]
    v_mfma_f32_16x16x32_bf16 v[96:99], v[184:187], v[160:163], v[96:99]
    v_mul_f32 v64, v25, v64
    v_mul_f32 v65, v25, v65
    v_mul_f32 v66, v25, v66
    v_mfma_f32_16x16x32_bf16 v[100:103], v[184:187], v[164:167], v[100:103]
    v_mul_f32 v67, v25, v67
    v_cvt_pk_bf16_f32 v192, v64, v65
    v_cvt_pk_bf16_f32 v193, v66, v67
    v_mfma_f32_16x16x32_bf16 v[104:107], v[184:187], v[168:171], v[104:107]
    v_mul_f32 v68, v27, v68
    v_mul_f32 v69, v27, v69
    v_mul_f32 v70, v27, v70
    v_mfma_f32_16x16x32_bf16 v[108:111], v[184:187], v[172:175], v[108:111]
    v_mul_f32 v71, v27, v71
    v_cvt_pk_bf16_f32 v194, v68, v69
    v_cvt_pk_bf16_f32 v195, v70, v71
    v_mfma_f32_16x16x32_bf16 v[112:115], v[156:159], v[128:131], v[112:115]
    buffer_store_dwordx4 v[192:195], v45, s[36:39], s66 offen offset:0 sc1
    v_mul_f32 v72, v29, v72
    v_mul_f32 v73, v29, v73
    v_mfma_f32_16x16x32_bf16 v[116:119], v[156:159], v[132:135], v[116:119]
    v_mul_f32 v74, v29, v74
    v_mul_f32 v75, v29, v75
    v_cvt_pk_bf16_f32 v196, v72, v73
    v_mfma_f32_16x16x32_bf16 v[120:123], v[156:159], v[136:139], v[120:123]
    v_cvt_pk_bf16_f32 v197, v74, v75
    v_mul_f32 v76, v31, v76
    v_mul_f32 v77, v31, v77
    v_mfma_f32_16x16x32_bf16 v[124:127], v[156:159], v[140:143], v[124:127]
    v_mul_f32 v78, v31, v78
    v_mul_f32 v79, v31, v79
    v_cvt_pk_bf16_f32 v198, v76, v77
    v_mfma_f32_16x16x32_bf16 v[112:115], v[188:191], v[160:163], v[112:115]
    v_cvt_pk_bf16_f32 v199, v78, v79
    buffer_store_dwordx4 v[196:199], v45, s[36:39], s66 offen offset:256 sc1
    v_mul_f32 v80, v25, v80
    v_mfma_f32_16x16x32_bf16 v[116:119], v[188:191], v[164:167], v[116:119]
    v_mul_f32 v81, v25, v81
    v_mul_f32 v82, v25, v82
    v_mul_f32 v83, v25, v83
    v_mfma_f32_16x16x32_bf16 v[120:123], v[188:191], v[168:171], v[120:123]
    v_cvt_pk_bf16_f32 v200, v80, v81
    v_cvt_pk_bf16_f32 v201, v82, v83
    v_mul_f32 v84, v27, v84
    v_mfma_f32_16x16x32_bf16 v[124:127], v[188:191], v[172:175], v[124:127]
    v_mul_f32 v85, v27, v85
    v_mul_f32 v86, v27, v86
    v_mul_f32 v87, v27, v87
    s_waitcnt lgkmcnt(0)
    v_mfma_f32_16x16x16_bf16 v[96:99], v[52:53], v[56:57], v[96:99]
    v_cvt_pk_bf16_f32 v202, v84, v85
    v_cvt_pk_bf16_f32 v203, v86, v87
    v_mfma_f32_16x16x16_bf16 v[100:103], v[52:53], v[58:59], v[100:103]
    buffer_store_dwordx4 v[200:203], v45, s[36:39], s68 offen offset:0 sc1
    v_mul_f32 v88, v29, v88
    v_mfma_f32_16x16x16_bf16 v[104:107], v[52:53], v[60:61], v[104:107]
    v_mul_f32 v89, v29, v89
    v_mul_f32 v90, v29, v90
    v_mfma_f32_16x16x16_bf16 v[108:111], v[52:53], v[62:63], v[108:111]
    v_mul_f32 v91, v29, v91
    v_cvt_pk_bf16_f32 v204, v88, v89
    v_mfma_f32_16x16x16_bf16 v[112:115], v[54:55], v[56:57], v[112:115]
    v_cvt_pk_bf16_f32 v205, v90, v91
    v_mul_f32 v92, v31, v92
    v_mfma_f32_16x16x16_bf16 v[116:119], v[54:55], v[58:59], v[116:119]
    v_mul_f32 v93, v31, v93
    v_mul_f32 v94, v31, v94
    v_mfma_f32_16x16x16_bf16 v[120:123], v[54:55], v[60:61], v[120:123]
    v_mul_f32 v95, v31, v95
    v_cvt_pk_bf16_f32 v206, v92, v93
    v_mfma_f32_16x16x16_bf16 v[124:127], v[54:55], v[62:63], v[124:127]
    v_cvt_pk_bf16_f32 v207, v94, v95
    buffer_store_dwordx4 v[204:207], v45, s[36:39], s68 offen offset:256 sc1
    v_mul_f32 v96, v25, v96
    v_mul_f32 v97, v25, v97
    v_mul_f32 v98, v25, v98
    v_mul_f32 v99, v25, v99
    v_cvt_pk_bf16_f32 v192, v96, v97
    v_cvt_pk_bf16_f32 v193, v98, v99
    v_mul_f32 v100, v27, v100
    v_mul_f32 v101, v27, v101
    v_mul_f32 v102, v27, v102
    v_mul_f32 v103, v27, v103
    v_cvt_pk_bf16_f32 v194, v100, v101
    v_cvt_pk_bf16_f32 v195, v102, v103
    buffer_store_dwordx4 v[192:195], v45, s[36:39], s67 offen offset:0 sc1
    v_mul_f32 v104, v29, v104
    v_mul_f32 v105, v29, v105
    v_mul_f32 v106, v29, v106
    v_mul_f32 v107, v29, v107
    v_cvt_pk_bf16_f32 v196, v104, v105
    v_cvt_pk_bf16_f32 v197, v106, v107
    v_mul_f32 v108, v31, v108
    v_mul_f32 v109, v31, v109
    v_mul_f32 v110, v31, v110
    v_mul_f32 v111, v31, v111
    v_cvt_pk_bf16_f32 v198, v108, v109
    v_cvt_pk_bf16_f32 v199, v110, v111
    buffer_store_dwordx4 v[196:199], v45, s[36:39], s67 offen offset:256 sc1
    v_mul_f32 v112, v25, v112
    v_mul_f32 v113, v25, v113
    v_mul_f32 v114, v25, v114
    v_mul_f32 v115, v25, v115
    v_cvt_pk_bf16_f32 v200, v112, v113
    v_cvt_pk_bf16_f32 v201, v114, v115
    v_mul_f32 v116, v27, v116
    v_mul_f32 v117, v27, v117
    v_mul_f32 v118, v27, v118
    v_mul_f32 v119, v27, v119
    v_cvt_pk_bf16_f32 v202, v116, v117
    v_cvt_pk_bf16_f32 v203, v118, v119
    buffer_store_dwordx4 v[200:203], v45, s[36:39], s69 offen offset:0 sc1
    v_mul_f32 v120, v29, v120
    v_mul_f32 v121, v29, v121
    v_mul_f32 v122, v29, v122
    v_mul_f32 v123, v29, v123
    v_cvt_pk_bf16_f32 v204, v120, v121
    v_cvt_pk_bf16_f32 v205, v122, v123
    v_mul_f32 v124, v31, v124
    v_mul_f32 v125, v31, v125
    v_mul_f32 v126, v31, v126
    v_mul_f32 v127, v31, v127
    v_cvt_pk_bf16_f32 v206, v124, v125
    v_cvt_pk_bf16_f32 v207, v126, v127
    buffer_store_dwordx4 v[204:207], v45, s[36:39], s69 offen offset:256 sc1
    s_barrier
    s_waitcnt vmcnt(0)
    v_mov_b32 v2, 163776
    v_mov_b32 v3, 1
    s_mov_b64 exec, 1
    ds_add_rtn_u32 v2, v2, v3
    s_waitcnt lgkmcnt(0)
    v_readfirstlane_b32 s3, v2
    s_nop 0
    s_cmp_eq_u32 s3, 3
    s_cbranch_scc0 Lsig_5
    s_mov_b64 exec, 0xffff
    buffer_atomic_add v3, v44, s[36:39], 0 offen sc1
Lsig_5:
    s_mov_b64 exec, -1
    s_branch L_p2
L_idle:
    s_cmp_lt_u32 s44, 4
    s_cbranch_scc1 L_idle_c
    v_lshrrev_b32 v16, 4, v1
    v_and_b32 v17, 15, v1
    v_mul_u32_u24 v4, 1280, v16
    v_lshl_add_u32 v4, v17, 4, v4
    s_mul_i32 s56, s48, 40
    s_lshl_b32 s3, s57, 2
    s_add_u32 s56, s56, s3
    s_mul_i32 s54, s56, 1280
    s_cmp_lt_u32 s57, 2
    s_cselect_b32 s58, 0, 1073741824
    buffer_load_dwordx4 v[160:163], v4, s[16:19], s54 offen offset:0
    buffer_load_dwordx4 v[164:167], v4, s[16:19], s54 offen offset:256
    buffer_load_dwordx4 v[168:171], v4, s[16:19], s54 offen offset:512
    buffer_load_dwordx4 v[172:175], v4, s[16:19], s54 offen offset:768
    buffer_load_dwordx4 v[176:179], v4, s[16:19], s54 offen offset:1024
    s_add_u32 s54, s54, 20480
    buffer_load_dwordx4 v[180:183], v4, s[16:19], s54 offen offset:0
    buffer_load_dwordx4 v[184:187], v4, s[16:19], s54 offen offset:256
    buffer_load_dwordx4 v[188:191], v4, s[16:19], s54 offen offset:512
    buffer_load_dwordx4 v[192:195], v4, s[16:19], s54 offen offset:768
    buffer_load_dwordx4 v[196:199], v4, s[16:19], s54 offen offset:1024
    s_add_u32 s54, s54, 20480
    s_add_u32 s54, s54, s58
    buffer_load_dwordx4 v[200:203], v4, s[16:19], s54 offen offset:0
    buffer_load_dwordx4 v[204:207], v4, s[16:19], s54 offen offset:256
    buffer_load_dwordx4 v[208:211], v4, s[16:19], s54 offen offset:512
    buffer_load_dwordx4 v[212:215], v4, s[16:19], s54 offen offset:768
    buffer_load_dwordx4 v[216:219], v4, s[16:19], s54 offen offset:1024
    s_add_u32 s54, s54, 20480
    v_mov_b32 v7, 0x3f803f80
    v_lshlrev_b32 v16, 3, v16
    v_mov_b32 v9, 0
    s_lshl_b32 s55, s56, 3
    s_add_u32 s55, s55, 114688
    v_cmp_eq_u32 vcc, 0, v17
    s_waitcnt vmcnt(0)
    v_mov_b32 v5, 0
    v_dot2c_f32_bf16 v5, v160, v7
    v_dot2c_f32_bf16 v5, v161, v7
    v_dot2c_f32_bf16 v5, v162, v7
    v_dot2c_f32_bf16 v5, v163, v7
    v_dot2c_f32_bf16 v5, v164, v7
    v_dot2c_f32_bf16 v5, v165, v7
    v_dot2c_f32_bf16 v5, v166, v7
    v_dot2c_f32_bf16 v5, v167, v7
    v_dot2c_f32_bf16 v5, v168, v7
    v_dot2c_f32_bf16 v5, v169, v7
    v_dot2c_f32_bf16 v5, v170, v7
    v_dot2c_f32_bf16 v5, v171, v7
    v_dot2c_f32_bf16 v5, v172, v7
    v_dot2c_f32_bf16 v5, v173, v7
    v_dot2c_f32_bf16 v5, v174, v7
    v_dot2c_f32_bf16 v5, v175, v7
    v_dot2c_f32_bf16 v5, v176, v7
    v_dot2c_f32_bf16 v5, v177, v7
    v_dot2c_f32_bf16 v5, v178, v7
    v_dot2c_f32_bf16 v5, v179, v7
    s_nop 2
    v_add_f32_dpp v5, v5, v5 row_ror:8 row_mask:0xf bank_mask:0xf
    s_nop 1
    v_add_f32_dpp v5, v5, v5 row_ror:4 row_mask:0xf bank_mask:0xf
    s_nop 1
    v_add_f32_dpp v5, v5, v5 row_ror:2 row_mask:0xf bank_mask:0xf
    s_nop 1
    v_add_f32_dpp v5, v5, v5 row_ror:1 row_mask:0xf bank_mask:0xf
    v_mul_f32 v5, 0xbacccccd, v5
    v_cvt_pk_bf16_f32 v8, v5, v5
    v_and_b32 v8, 0xffff0000, v8
    v_sub_f32 v5, v5, v8
    v_cvt_pk_bf16_f32 v8, v8, v5
    s_mov_b64 exec, vcc
    buffer_store_dwordx2 v[8:9], v16, s[36:39], s55 offen offset:0 sc1
    s_mov_b64 exec, -1
    v_mov_b32 v5, 0
    v_dot2c_f32_bf16 v5, v180, v7
    v_dot2c_f32_bf16 v5, v181, v7
    v_dot2c_f32_bf16 v5, v182, v7
    v_dot2c_f32_bf16 v5, v183, v7
    v_dot2c_f32_bf16 v5, v184, v7
    v_dot2c_f32_bf16 v5, v185, v7
    v_dot2c_f32_bf16 v5, v186, v7
    v_dot2c_f32_bf16 v5, v187, v7
    v_dot2c_f32_bf16 v5, v188, v7
    v_dot2c_f32_bf16 v5, v189, v7
    v_dot2c_f32_bf16 v5, v190, v7
    v_dot2c_f32_bf16 v5, v191, v7
    v_dot2c_f32_bf16 v5, v192, v7
    v_dot2c_f32_bf16 v5, v193, v7
    v_dot2c_f32_bf16 v5, v194, v7
    v_dot2c_f32_bf16 v5, v195, v7
    v_dot2c_f32_bf16 v5, v196, v7
    v_dot2c_f32_bf16 v5, v197, v7
    v_dot2c_f32_bf16 v5, v198, v7
    v_dot2c_f32_bf16 v5, v199, v7
    s_nop 2
    v_add_f32_dpp v5, v5, v5 row_ror:8 row_mask:0xf bank_mask:0xf
    s_nop 1
    v_add_f32_dpp v5, v5, v5 row_ror:4 row_mask:0xf bank_mask:0xf
    s_nop 1
    v_add_f32_dpp v5, v5, v5 row_ror:2 row_mask:0xf bank_mask:0xf
    s_nop 1
    v_add_f32_dpp v5, v5, v5 row_ror:1 row_mask:0xf bank_mask:0xf
    v_mul_f32 v5, 0xbacccccd, v5
    v_cvt_pk_bf16_f32 v8, v5, v5
    v_and_b32 v8, 0xffff0000, v8
    v_sub_f32 v5, v5, v8
    v_cvt_pk_bf16_f32 v8, v8, v5
    s_mov_b64 exec, vcc
    buffer_store_dwordx2 v[8:9], v16, s[36:39], s55 offen offset:128 sc1
    s_mov_b64 exec, -1
    s_add_u32 s55, s55, s58
    v_mov_b32 v5, 0
    v_dot2c_f32_bf16 v5, v200, v7
    v_dot2c_f32_bf16 v5, v201, v7
    v_dot2c_f32_bf16 v5, v202, v7
    v_dot2c_f32_bf16 v5, v203, v7
    v_dot2c_f32_bf16 v5, v204, v7
    v_dot2c_f32_bf16 v5, v205, v7
    v_dot2c_f32_bf16 v5, v206, v7
    v_dot2c_f32_bf16 v5, v207, v7
    v_dot2c_f32_bf16 v5, v208, v7
    v_dot2c_f32_bf16 v5, v209, v7
    v_dot2c_f32_bf16 v5, v210, v7
    v_dot2c_f32_bf16 v5, v211, v7
    v_dot2c_f32_bf16 v5, v212, v7
    v_dot2c_f32_bf16 v5, v213, v7
    v_dot2c_f32_bf16 v5, v214, v7
    v_dot2c_f32_bf16 v5, v215, v7
    v_dot2c_f32_bf16 v5, v216, v7
    v_dot2c_f32_bf16 v5, v217, v7
    v_dot2c_f32_bf16 v5, v218, v7
    v_dot2c_f32_bf16 v5, v219, v7
    s_nop 2
    v_add_f32_dpp v5, v5, v5 row_ror:8 row_mask:0xf bank_mask:0xf
    s_nop 1
    v_add_f32_dpp v5, v5, v5 row_ror:4 row_mask:0xf bank_mask:0xf
    s_nop 1
    v_add_f32_dpp v5, v5, v5 row_ror:2 row_mask:0xf bank_mask:0xf
    s_nop 1
    v_add_f32_dpp v5, v5, v5 row_ror:1 row_mask:0xf bank_mask:0xf
    v_mul_f32 v5, 0xbacccccd, v5
    v_cvt_pk_bf16_f32 v8, v5, v5
    v_and_b32 v8, 0xffff0000, v8
    v_sub_f32 v5, v5, v8
    v_cvt_pk_bf16_f32 v8, v8, v5
    s_mov_b64 exec, vcc
    buffer_store_dwordx2 v[8:9], v16, s[36:39], s55 offen offset:256 sc1
    s_mov_b64 exec, -1
    s_branch L_idle_d
L_idle_c:
    s_cmp_lt_u32 s44, 2
    s_cbranch_scc0 L_idle_d
    v_mov_b32 v20, 0
    v_mov_b32 v21, 8
    v_and_b32 v23, 7, v1
    v_lshlrev_b32 v23, 12, v23
    v_bfe_u32 v2, v1, 3, 1
    v_lshl_add_u32 v23, v2, 7, v23
    s_and_b32 s3, s64, 3
    s_lshl_b32 s3, s3, 10
    s_lshr_b32 s4, s64, 2
    s_lshl_b32 s4, s4, 8
    s_add_u32 s3, s3, s4
    s_add_u32 s3, s3, 0
    v_add_u32 v23, s3, v23
    s_mov_b32 s3, 0
Lpoll_6:
    buffer_load_dword v22, v20, s[40:43], 0 offen sc1
    s_add_u32 s3, s3, 1
    s_waitcnt vmcnt(0)
    v_cmp_lt_u32 vcc, v22, v21
    s_cmp_gt_u32 s3, 262144
    s_cbranch_scc1 Lpollx_7
    s_cbranch_vccnz Lpoll_6
Lpollx_7:
    v_mov_b32 v21, 1
    s_mov_b64 exec, 0xffff
    buffer_atomic_add v21, v23, s[36:39], 0 offen sc1
    s_mov_b64 exec, -1
L_idle_d:
    s_waitcnt vmcnt(0) lgkmcnt(0)
    s_barrier
    s_cmp_ge_u32 s44, 4
    s_cbranch_scc1 L_idle_e
    v_lshlrev_b32 v4, 7, v0
    v_add_u32 v4, 32776, v4
    v_mov_b32 v21, 1
    buffer_atomic_add v21, v4, s[36:39], 0 offen sc1
L_idle_e:
    s_cmp_ge_u32 s44, 4
    s_cbranch_scc1 L_p1_lt
    s_barrier
L_p2:
    s_and_b32 s3, s47, 7
    s_lshl_b32 s52, s45, 3
    s_add_u32 s52, s52, s3
    s_lshr_b32 s3, s47, 3
    s_lshl_b32 s53, s46, 2
    s_add_u32 s53, s53, s3
    s_lshr_b32 s94, s52, 1
    s_lshl_b32 s95, s53, 1
    s_and_b32 s3, s47, 1
    s_add_u32 s95, s95, s3
    s_lshr_b32 s50, s47, 2
    s_and_b32 s3, s2, 7
    s_lshl_b32 s51, s3, 2
    s_and_b32 s3, s47, 3
    s_add_u32 s51, s51, s3
    v_lshrrev_b32 v2, 5, v1
    v_bfe_u32 v3, v1, 4, 1
    v_and_b32 v4, 15, v1
    v_lshlrev_b32 v5, 14, v3
    v_lshl_add_u32 v5, v2, 8, v5
    v_lshl_add_u32 v240, v4, 4, v5
    v_lshlrev_b32 v6, 12, v3
    v_lshl_add_u32 v241, v4, 3, v6
    v_mov_b32 v16, -1
    v_mov_b32 v17, -1
    v_mov_b32 v18, -1
    v_mov_b32 v19, -1
    v_mov_b32 v242, 1
    s_lshl_b32 s3, s50, 4
    s_lshl_b32 s4, s44, 1
    s_add_u32 s3, s3, s4
    s_lshl_b32 s4, s3, 14
    s_lshl_b32 s5, s51, 9
    s_add_u32 s4, s4, s5
    s_add_u32 s90, s4, 9437184
    s_lshl_b32 s3, s3, 12
    s_lshl_b32 s5, s51, 7
    s_add_u32 s3, s3, s5
    s_add_u32 s91, s3, 11534336
    s_lshl_b32 s89, s2, 7
    v_lshrrev_b32 v2, 5, v1
    v_and_b32 v3, 31, v1
    v_lshlrev_b32 v4, 3, v0
    v_add_u32 v4, 20480, v4
    v_mov_b32 v6, 0x3f800000
    v_mov_b32 v7, 0
    s_cmp_eq_u32 s50, 0
    s_cselect_b32 s3, 4, 0
    s_cmp_lt_u32 s44, s3
    s_cselect_b32 s3, 0xf149, 0
    v_or_b32 v6, s3, v6
    ds_write_b64 v4, v[6:7]
    v_lshlrev_b32 v4, 2, v2
    v_sub_u32 v4, v3, v4
    v_mov_b32 v5, 0xf149f2ca
    v_cmp_le_i32 vcc, 0, v4
    v_mov_b32 v176, v5
    s_nop 0
    v_cndmask_b32 v160, 0, v5, vcc
    v_sub_f32 v176, v5, v160
    v_cmp_le_i32 vcc, 1, v4
    v_mov_b32 v177, v5
    s_nop 0
    v_cndmask_b32 v161, 0, v5, vcc
    v_sub_f32 v177, v5, v161
    v_cmp_le_i32 vcc, 2, v4
    v_mov_b32 v178, v5
    s_nop 0
    v_cndmask_b32 v162, 0, v5, vcc
    v_sub_f32 v178, v5, v162
    v_cmp_le_i32 vcc, 3, v4
    v_mov_b32 v179, v5
    s_nop 0
    v_cndmask_b32 v163, 0, v5, vcc
    v_sub_f32 v179, v5, v163
    v_cmp_le_i32 vcc, 8, v4
    v_mov_b32 v180, v5
    s_nop 0
    v_cndmask_b32 v164, 0, v5, vcc
    v_sub_f32 v180, v5, v164
    v_cmp_le_i32 vcc, 9, v4
    v_mov_b32 v181, v5
    s_nop 0
    v_cndmask_b32 v165, 0, v5, vcc
    v_sub_f32 v181, v5, v165
    v_cmp_le_i32 vcc, 10, v4
    v_mov_b32 v182, v5
    s_nop 0
    v_cndmask_b32 v166, 0, v5, vcc
    v_sub_f32 v182, v5, v166
    v_cmp_le_i32 vcc, 11, v4
    v_mov_b32 v183, v5
    s_nop 0
    v_cndmask_b32 v167, 0, v5, vcc
    v_sub_f32 v183, v5, v167
    v_cmp_le_i32 vcc, 16, v4
    v_mov_b32 v184, v5
    s_nop 0
    v_cndmask_b32 v168, 0, v5, vcc
    v_sub_f32 v184, v5, v168
    v_cmp_le_i32 vcc, 17, v4
    v_mov_b32 v185, v5
    s_nop 0
    v_cndmask_b32 v169, 0, v5, vcc
    v_sub_f32 v185, v5, v169
    v_cmp_le_i32 vcc, 18, v4
    v_mov_b32 v186, v5
    s_nop 0
    v_cndmask_b32 v170, 0, v5, vcc
    v_sub_f32 v186, v5, v170
    v_cmp_le_i32 vcc, 19, v4
    v_mov_b32 v187, v5
    s_nop 0
    v_cndmask_b32 v171, 0, v5, vcc
    v_sub_f32 v187, v5, v171
    v_cmp_le_i32 vcc, 24, v4
    v_mov_b32 v188, v5
    s_nop 0
    v_cndmask_b32 v172, 0, v5, vcc
    v_sub_f32 v188, v5, v172
    v_cmp_le_i32 vcc, 25, v4
    v_mov_b32 v189, v5
    s_nop 0
    v_cndmask_b32 v173, 0, v5, vcc
    v_sub_f32 v189, v5, v173
    v_cmp_le_i32 vcc, 26, v4
    v_mov_b32 v190, v5
    s_nop 0
    v_cndmask_b32 v174, 0, v5, vcc
    v_sub_f32 v190, v5, v174
    v_cmp_le_i32 vcc, 27, v4
    v_mov_b32 v191, v5
    s_nop 0
    v_cndmask_b32 v175, 0, v5, vcc
    v_sub_f32 v191, v5, v175
    s_lshl_b32 s3, s44, 8
    v_lshlrev_b32 v8, 12, v2
    v_lshl_add_u32 v8, v3, 3, v8
    v_add_u32 v8, s3, v8
    v_and_b32 v4, 3, v1
    v_mul_u32_u24 v5, 4128, v4
    v_add_u32 v5, 24672, v5
    v_mov_b32 v6, 20480
    v_mov_b32 v7, 41184
    v_cmp_eq_u32 vcc, 0, v4
    v_bfe_u32 v4, v1, 4, 1
    s_nop 0
    v_cndmask_b32 v6, v6, v7, vcc
    v_cmp_eq_u32 vcc, 0, v4
    v_bfe_u32 v4, v1, 2, 2
    s_nop 0
    v_cndmask_b32 v9, v6, v5, vcc
    v_lshl_add_u32 v4, v2, 2, v4
    v_lshl_add_u32 v9, v4, 3, v9
    v_add_u32 v9, s3, v9
    v_cmp_eq_u32 vcc, 0, v2
    v_mov_b32 v5, 0x3f803f80
    v_mov_b32 v6, 0x3f80
    v_cndmask_b32 v30, 0, v5, vcc
    v_mov_b32 v7, 0
    v_cndmask_b32 v31, 0, v6, vcc
    v_lshlrev_b32 v10, 4, v1
    s_and_b32 s4, s44, 2
    s_or_b32 s4, s4, s50
    s_cmp_eq_u32 s4, 0
    s_cselect_b32 s4, 1073741824, 0
    v_add_u32 v10, s4, v10
    v_lshlrev_b32 v11, 14, v2
    v_lshl_add_u32 v11, v3, 3, v11
    s_lshl_b32 s5, s50, 2
    v_and_b32 v232, 3, v1
    v_lshlrev_b32 v232, 13, v232
    v_bfe_u32 v4, v1, 2, 1
    v_lshl_add_u32 v232, v4, 7, v232
    v_bfe_u32 v4, v1, 3, 2
    v_lshl_add_u32 v232, v4, 10, v232
    s_and_b32 s3, s5, 7
    s_lshl_b32 s3, s3, 10
    s_lshr_b32 s4, s5, 3
    s_lshl_b32 s4, s4, 8
    s_add_u32 s3, s3, s4
    s_add_u32 s3, s3, 20
    v_add_u32 v232, s3, v232
    v_and_b32 v233, 3, v1
    v_lshlrev_b32 v233, 11, v233
    v_bfe_u32 v4, v1, 2, 2
    v_lshl_add_u32 v233, v4, 8, v233
    s_and_b32 s3, s2, 201
    s_lshl_b32 s3, s3, 7
    s_lshl_b32 s4, s46, 7
    s_add_u32 s3, s3, 32780
    v_add_u32 v233, s3, v233
    v_and_b32 v234, 7, v1
    v_lshlrev_b32 v234, 10, v234
    v_bfe_u32 v4, v1, 3, 2
    v_lshl_add_u32 v234, v4, 8, v234
    s_and_b32 s3, s53, 3
    s_lshl_b32 s3, s3, 13
    s_add_u32 s3, s3, s4
    s_add_u32 s3, s3, 32784
    v_add_u32 v234, s3, v234
    s_mul_i32 s54, s51, 5
    s_lshl_b32 s54, s54, 14
    s_lshl_b32 s5, s50, 11
    s_add_u32 s54, s54, s5
    s_and_b32 s6, s44, 3
    s_lshl_b32 s6, s6, 10
    s_add_u32 s58, s54, s6
    s_add_u32 s58, s58, 1046528
    s_lshl_b32 s5, s44, 8
    s_add_u32 s54, s54, s5
    s_add_u32 s54, s54, 1048576
    s_mov_b32 s7, s6
    v_lshlrev_b32 v13, 4, v1
    v_mul_u32_u24 v4, 26, v1
    v_lshrrev_b32 v4, 8, v4
    v_mul_u32_u24 v5, 10, v4
    v_sub_u32 v5, v1, v5
    v_mul_u32_u24 v12, 1280, v4
    v_lshl_add_u32 v12, v5, 4, v12
    s_mul_i32 s59, s44, 102400
    s_mul_i32 s5, s53, 160
    s_add_u32 s59, s59, s5
    s_add_u32 s59, s59, 69120
    s_mul_i32 s60, s44, 12800
    s_add_u32 s60, s60, 63936
    s_cmp_ge_u32 s44, 5
    s_cselect_b32 s3, 5, 0
    s_sub_u32 s61, s44, s3
    s_lshl_b32 s61, s61, 10
    s_cmp_eq_u32 s44, 7
    s_cbranch_scc0 L_p2_nopoll
    s_cmp_eq_u32 s50, 0
    s_cselect_b32 s5, 6, 10
    s_lshl_b32 s6, 1, s51
    s_and_b32 s6, s6, 34082880
    s_cselect_b32 s6, 1, 0
    s_lshl_b32 s5, s5, s6
    v_and_b32 v4, 15, v1
    v_lshlrev_b32 v4, 2, v4
    s_lshl_b32 s3, s2, 7
    v_add_u32 v4, s3, v4
    v_bfe_u32 v5, v1, 4, 1
    v_lshl_add_u32 v4, v5, 15, v4
    v_mov_b32 v5, 0
    v_writelane_b32 v5, s5, 1
    v_writelane_b32 v5, 16, 18
    s_mov_b32 s3, 0
Lpoll_8:
    buffer_load_dword v14, v4, s[36:39], 0 offen sc1
    s_add_u32 s3, s3, 1
    s_waitcnt vmcnt(0)
    v_cmp_lt_u32 vcc, v14, v5
    s_cmp_gt_u32 s3, 262144
    s_cbranch_scc1 Lpollx_9
    s_cbranch_vccnz Lpoll_8
Lpollx_9:
L_p2_nopoll:
    s_waitcnt lgkmcnt(0)
    s_barrier
    s_cmp_ge_u32 s44, 4
    s_cselect_b32 s3, 49152, 0
    s_cselect_b32 s4, 12288, 0
    s_add_i32 s3, s3, 2621440
    s_add_i32 s4, s4, 0
    s_add_i32 m0, s4, s7
    s_add_i32 s3, s3, s58
    s_cmp_ge_u32 s44, 4
    buffer_load_dwordx4 v10, s[36:39], s3 offen sc1 lds
    s_cselect_b32 s3, 49152, 0
    s_cselect_b32 s4, 12288, 0
    s_add_i32 s3, s3, 2637824
    s_add_i32 s4, s4, 4096
    s_add_i32 m0, s4, s7
    s_add_i32 s3, s3, s58
    s_cmp_ge_u32 s44, 4
    buffer_load_dwordx4 v10, s[36:39], s3 offen sc1 lds
    buffer_load_dwordx2 v[24:25], v11, s[36:39], s54 offen sc1
    s_add_u32 s54, s54, 32768
    buffer_load_dwordx2 v[26:27], v11, s[36:39], s54 offen sc1
    s_add_u32 s54, s54, 32768
    buffer_load_dwordx2 v[28:29], v11, s[36:39], s54 offen sc1
    s_add_u32 s54, s54, 32768
    s_cmp_ge_u32 s44, 4
    s_cselect_b32 s3, 2588672, 0
    s_cselect_b32 s4, 16480, 0
    s_add_i32 s3, s3, 2654208
    s_add_i32 s4, s4, 8192
    s_add_i32 m0, s4, s7
    s_add_i32 s3, s3, s58
    s_cmp_ge_u32 s44, 4
    buffer_load_dwordx4 v10, s[36:39], s3 offen sc1 lds
    v_cmp_gt_u32 vcc, 32, v1
    v_mov_b32 v6, 0x3f80
    v_mov_b32 v7, 0
    s_waitcnt vmcnt(0)
    v_cndmask_b32 v28, v6, v28, vcc
    s_cselect_b32 s3, -32768, 0
    s_cselect_b32 s4, 4294959040, 0
    s_add_i32 s3, s3, 5292032
    s_add_i32 s4, s4, 37056
    s_add_i32 m0, s4, s7
    s_add_i32 s3, s3, s58
    s_cmp_ge_u32 s44, 4
    buffer_load_dwordx4 v10, s[36:39], s3 offen sc1 lds
    s_cselect_b32 s3, -32768, 0
    s_cselect_b32 s4, 4294959040, 0
    s_add_i32 s3, s3, 5308416
    s_add_i32 s4, s4, 41184
    s_add_i32 m0, s4, s7
    s_add_i32 s3, s3, s58
    s_cmp_ge_u32 s44, 4
    buffer_load_dwordx4 v10, s[36:39], s3 offen sc1 lds
    s_barrier
    v_cndmask_b32 v29, v7, v29, vcc
    ds_read_b64 v[32:33], v8 offset:2048
    ds_read_b64 v[34:35], v8 offset:10240
    ds_read_b64 v[36:37], v8 offset:18432
    ds_read_b64 v[38:39], v8 offset:1792
    ds_read_b64 v[40:41], v8 offset:9984
    ds_read_b64 v[42:43], v8 offset:18176
    ds_read_b64 v[44:45], v8 offset:1536
    ds_read_b64 v[46:47], v8 offset:9728
    ds_read_b64 v[48:49], v8 offset:17920
    s_waitcnt lgkmcnt(6)
    v_mfma_f32_32x32x16_bf16 v[64:79], v[32:35], v[24:27], v[176:191]
    v_mfma_f32_32x32x8_bf16 v[64:79], v[36:37], v[28:29], v[64:79]
    ds_read_b64 v[32:33], v8 offset:1280
    ds_read_b64 v[34:35], v8 offset:9472
    ds_read_b64 v[36:37], v8 offset:17664
    s_waitcnt lgkmcnt(6)
    v_mfma_f32_32x32x16_bf16 v[80:95], v[38:41], v[24:27], 0
    v_mfma_f32_32x32x8_bf16 v[80:95], v[42:43], v[28:29], v[80:95]
    ds_read_b64 v[38:39], v8 offset:1024
    ds_read_b64 v[40:41], v8 offset:9216
    ds_read_b64 v[42:43], v8 offset:17408
    s_nop 2
    v_exp_f32 v64, v64
    v_exp_f32 v65, v65
    v_exp_f32 v66, v66
    v_exp_f32 v67, v67
    v_exp_f32 v68, v68
    v_exp_f32 v69, v69
    v_exp_f32 v70, v70
    v_exp_f32 v71, v71
    v_cvt_pk_bf16_f32 v64, v64, v65
    v_cvt_pk_bf16_f32 v65, v66, v67
    v_cvt_pk_bf16_f32 v66, v68, v69
    v_cvt_pk_bf16_f32 v67, v70, v71
    v_exp_f32 v72, v72
    v_exp_f32 v73, v73
    v_exp_f32 v74, v74
    v_exp_f32 v75, v75
    v_exp_f32 v76, v76
    v_exp_f32 v77, v77
    s_waitcnt lgkmcnt(6)
    v_mfma_f32_32x32x16_bf16 v[96:111], v[44:47], v[24:27], 0
    v_exp_f32 v78, v78
    v_exp_f32 v79, v79
    v_mfma_f32_32x32x8_bf16 v[96:111], v[48:49], v[28:29], v[96:111]
    ds_read_b64 v[44:45], v8 offset:768
    ds_read_b64 v[46:47], v8 offset:8960
    ds_read_b64 v[48:49], v8 offset:17152
    v_cvt_pk_bf16_f32 v72, v72, v73
    v_cvt_pk_bf16_f32 v73, v74, v75
    v_cvt_pk_bf16_f32 v74, v76, v77
    v_cvt_pk_bf16_f32 v75, v78, v79
    v_exp_f32 v80, v80
    v_exp_f32 v81, v81
    v_exp_f32 v82, v82
    v_exp_f32 v83, v83
    v_exp_f32 v84, v84
    v_exp_f32 v85, v85
    v_exp_f32 v86, v86
    v_exp_f32 v87, v87
    v_cvt_pk_bf16_f32 v80, v80, v81
    v_cvt_pk_bf16_f32 v81, v82, v83
    v_cvt_pk_bf16_f32 v82, v84, v85
    v_cvt_pk_bf16_f32 v83, v86, v87
    v_exp_f32 v88, v88
    v_exp_f32 v89, v89
    v_exp_f32 v90, v90
    v_exp_f32 v91, v91
    v_exp_f32 v92, v92
    v_exp_f32 v93, v93
    s_waitcnt lgkmcnt(6)
    v_mfma_f32_32x32x16_bf16 v[112:127], v[32:35], v[24:27], 0
    v_exp_f32 v94, v94
    v_exp_f32 v95, v95
    v_mfma_f32_32x32x8_bf16 v[112:127], v[36:37], v[28:29], v[112:127]
    ds_read_b64 v[32:33], v8 offset:512
    ds_read_b64 v[34:35], v8 offset:8704
    ds_read_b64 v[36:37], v8 offset:16896
    v_cvt_pk_bf16_f32 v88, v88, v89
    v_cvt_pk_bf16_f32 v89, v90, v91
    v_cvt_pk_bf16_f32 v90, v92, v93
    v_cvt_pk_bf16_f32 v91, v94, v95
    s_waitcnt vmcnt(0)
    s_barrier
    ds_read_b64_tr_b16 v[50:51], v9 offset:2048
    ds_read_b64_tr_b16 v[52:53], v9 offset:2112
    ds_read_b64_tr_b16 v[54:55], v9 offset:2176
    ds_read_b64_tr_b16 v[56:57], v9 offset:2240
    ds_read_b64_tr_b16 v[58:59], v9 offset:1792
    ds_read_b64_tr_b16 v[60:61], v9 offset:1856
    s_cmp_ge_u32 s44, 4
    s_cbranch_scc0 Lrts_10
    buffer_store_dwordx4 v[128:131], v153, s[36:39], 0 offen offset:0 sc1
    buffer_store_dwordx4 v[132:135], v153, s[36:39], 0 offen offset:1024 sc1
    buffer_store_dwordx4 v[140:143], v157, s[36:39], 0 offen offset:0 sc1
    buffer_store_dwordx4 v[144:147], v157, s[36:39], 0 offen offset:1024 sc1
Lrts_10:
    v_exp_f32 v96, v96
    v_exp_f32 v97, v97
    s_waitcnt lgkmcnt(4)
    v_mfma_f32_32x32x16_bf16 v[208:223], v[50:53], v[64:67], 0
    ds_read_b64_tr_b16 v[50:51], v9 offset:1920
    ds_read_b64_tr_b16 v[52:53], v9 offset:1984
    v_exp_f32 v98, v98
    v_exp_f32 v99, v99
    s_waitcnt lgkmcnt(4)
    v_mfma_f32_32x32x16_bf16 v[208:223], v[54:57], v[72:75], v[208:223]
    ds_read_b64_tr_b16 v[54:55], v9 offset:1536
    ds_read_b64_tr_b16 v[56:57], v9 offset:1600
    v_exp_f32 v100, v100
    v_exp_f32 v101, v101
    v_exp_f32 v102, v102
    v_exp_f32 v103, v103
    v_cvt_pk_bf16_f32 v96, v96, v97
    v_cvt_pk_bf16_f32 v97, v98, v99
    v_cvt_pk_bf16_f32 v98, v100, v101
    v_cvt_pk_bf16_f32 v99, v102, v103
    s_cmp_eq_u32 s44, 0
    s_cbranch_scc0 Lncp_11
    s_getpc_b64 s[4:5]
Lpc_12:
    s_sub_u32 s4, s4, Lpc_12-sequential_preLN__sliding_block__glu_gated_bilinear__prompt_kernel
    s_subb_u32 s5, s5, 0
    v_lshlrev_b32 v4, 7, v1
    s_mul_i32 s3, s47, 768
    s_add_u32 s3, s3, L_p3-sequential_preLN__sliding_block__glu_gated_bilinear__prompt_kernel
    v_add_u32 v4, s3, v4
    v_min_u32 v4, 40832, v4
    s_mov_b64 exec, 0x3f
    global_load_dword v235, v4, s[4:5]
    s_mov_b64 exec, -1
Lncp_11:
    v_exp_f32 v104, v104
    v_exp_f32 v105, v105
    s_waitcnt lgkmcnt(4)
    v_mfma_f32_32x32x16_bf16 v[208:223], v[58:61], v[80:83], v[208:223]
    ds_read_b64_tr_b16 v[58:59], v9 offset:1664
    ds_read_b64_tr_b16 v[60:61], v9 offset:1728
    v_exp_f32 v106, v106
    v_exp_f32 v107, v107
    v_exp_f32 v108, v108
    v_exp_f32 v109, v109
    v_mfma_f32_32x32x16_bf16 v[64:79], v[38:41], v[24:27], 0
    v_exp_f32 v110, v110
    v_exp_f32 v111, v111
    v_mfma_f32_32x32x8_bf16 v[64:79], v[42:43], v[28:29], v[64:79]
    ds_read_b64 v[38:39], v8 offset:256
    ds_read_b64 v[40:41], v8 offset:8448
    ds_read_b64 v[42:43], v8 offset:16640
    v_cvt_pk_bf16_f32 v104, v104, v105
    v_cvt_pk_bf16_f32 v105, v106, v107
    v_cvt_pk_bf16_f32 v106, v108, v109
    v_cvt_pk_bf16_f32 v107, v110, v111
    s_mov_b32 m0, s60
    s_add_u32 s60, s60, 960
    buffer_load_dwordx4 v12, s[16:19], s59 offen lds
    s_add_u32 s59, s59, 7680
    v_exp_f32 v112, v112
    v_exp_f32 v113, v113
    s_waitcnt lgkmcnt(7)
    v_mfma_f32_32x32x16_bf16 v[208:223], v[50:53], v[88:91], v[208:223]
    ds_read_b64_tr_b16 v[50:51], v9 offset:1280
    ds_read_b64_tr_b16 v[52:53], v9 offset:1344
    v_exp_f32 v114, v114
    v_exp_f32 v115, v115
    v_exp_f32 v116, v116
    v_exp_f32 v117, v117
    v_exp_f32 v118, v118
    v_exp_f32 v119, v119
    v_cvt_pk_bf16_f32 v112, v112, v113
    v_cvt_pk_bf16_f32 v113, v114, v115
    v_cvt_pk_bf16_f32 v114, v116, v117
    v_cvt_pk_bf16_f32 v115, v118, v119
    s_mov_b32 m0, s60
    s_add_u32 s60, s60, 960
    buffer_load_dwordx4 v12, s[16:19], s59 offen lds
    s_add_u32 s59, s59, 7680
    v_exp_f32 v120, v120
    v_exp_f32 v121, v121
    s_waitcnt lgkmcnt(7)
    v_mfma_f32_32x32x16_bf16 v[208:223], v[54:57], v[96:99], v[208:223]
    ds_read_b64_tr_b16 v[54:55], v9 offset:1408
    ds_read_b64_tr_b16 v[56:57], v9 offset:1472
    v_exp_f32 v122, v122
    v_exp_f32 v123, v123
    v_exp_f32 v124, v124
    v_exp_f32 v125, v125
    v_mfma_f32_32x32x16_bf16 v[80:95], v[44:47], v[24:27], 0
    v_exp_f32 v126, v126
    v_exp_f32 v127, v127
    v_mfma_f32_32x32x8_bf16 v[80:95], v[48:49], v[28:29], v[80:95]
    ds_read_b64 v[44:45], v8 offset:0
    ds_read_b64 v[46:47], v8 offset:8192
    ds_read_b64 v[48:49], v8 offset:16384
    v_cvt_pk_bf16_f32 v120, v120, v121
    v_cvt_pk_bf16_f32 v121, v122, v123
    v_cvt_pk_bf16_f32 v122, v124, v125
    v_cvt_pk_bf16_f32 v123, v126, v127
    s_mov_b32 m0, s60
    s_add_u32 s60, s60, 960
    buffer_load_dwordx4 v12, s[16:19], s59 offen lds
    s_add_u32 s59, s59, 7680
    v_exp_f32 v64, v64
    v_exp_f32 v65, v65
    s_waitcnt lgkmcnt(10)
    v_mfma_f32_32x32x16_bf16 v[208:223], v[58:61], v[104:107], v[208:223]
    ds_read_b64_tr_b16 v[58:59], v9 offset:1024
    ds_read_b64_tr_b16 v[60:61], v9 offset:1088
    v_exp_f32 v66, v66
    v_exp_f32 v67, v67
    v_exp_f32 v68, v68
    v_exp_f32 v69, v69
    v_exp_f32 v70, v70
    v_exp_f32 v71, v71
    v_cvt_pk_bf16_f32 v64, v64, v65
    v_cvt_pk_bf16_f32 v65, v66, v67
    v_cvt_pk_bf16_f32 v66, v68, v69
    v_cvt_pk_bf16_f32 v67, v70, v71
    s_cmp_ge_u32 s44, 4
    s_cbranch_scc0 Lrtl_13
    buffer_load_dwordx4 v[136:139], v154, s[28:31], 0 offen
    buffer_load_dwordx4 v[148:151], v158, s[28:31], 0 offen
Lrtl_13:
    v_exp_f32 v72, v72
    v_exp_f32 v73, v73
    s_waitcnt lgkmcnt(7)
    v_mfma_f32_32x32x16_bf16 v[208:223], v[50:53], v[112:115], v[208:223]
    ds_read_b64_tr_b16 v[50:51], v9 offset:1152
    ds_read_b64_tr_b16 v[52:53], v9 offset:1216
    v_exp_f32 v74, v74
    v_exp_f32 v75, v75
    v_exp_f32 v76, v76
    v_exp_f32 v77, v77
    v_mfma_f32_32x32x16_bf16 v[96:111], v[32:35], v[24:27], 0
    v_exp_f32 v78, v78
    v_exp_f32 v79, v79
    v_mfma_f32_32x32x8_bf16 v[96:111], v[36:37], v[28:29], v[96:111]
    v_cvt_pk_bf16_f32 v72, v72, v73
    v_cvt_pk_bf16_f32 v73, v74, v75
    v_cvt_pk_bf16_f32 v74, v76, v77
    v_cvt_pk_bf16_f32 v75, v78, v79
    s_mov_b32 m0, s60
    s_add_u32 s60, s60, 960
    buffer_load_dwordx4 v12, s[16:19], s59 offen lds
    s_add_u32 s59, s59, 7680
    v_exp_f32 v80, v80
    v_exp_f32 v81, v81
    s_waitcnt lgkmcnt(7)
    v_mfma_f32_32x32x16_bf16 v[208:223], v[54:57], v[120:123], v[208:223]
    ds_read_b64_tr_b16 v[54:55], v9 offset:768
    ds_read_b64_tr_b16 v[56:57], v9 offset:832
    v_exp_f32 v82, v82
    v_exp_f32 v83, v83
    v_exp_f32 v84, v84
    v_exp_f32 v85, v85
    v_exp_f32 v86, v86
    v_exp_f32 v87, v87
    v_cvt_pk_bf16_f32 v80, v80, v81
    v_cvt_pk_bf16_f32 v81, v82, v83
    v_cvt_pk_bf16_f32 v82, v84, v85
    v_cvt_pk_bf16_f32 v83, v86, v87
    s_mov_b32 m0, s60
    s_add_u32 s60, s60, 960
    buffer_load_dwordx4 v12, s[16:19], s59 offen lds
    s_add_u32 s59, s59, 7680
    v_exp_f32 v88, v88
    v_exp_f32 v89, v89
    s_waitcnt lgkmcnt(4)
    v_mfma_f32_32x32x16_bf16 v[208:223], v[58:61], v[64:67], v[208:223]
    ds_read_b64_tr_b16 v[58:59], v9 offset:896
    ds_read_b64_tr_b16 v[60:61], v9 offset:960
    v_exp_f32 v90, v90
    v_exp_f32 v91, v91
    v_exp_f32 v92, v92
    v_exp_f32 v93, v93
    v_mfma_f32_32x32x16_bf16 v[112:127], v[38:41], v[24:27], 0
    v_exp_f32 v94, v94
    v_exp_f32 v95, v95
    v_mfma_f32_32x32x8_bf16 v[112:127], v[42:43], v[28:29], v[112:127]
    v_cvt_pk_bf16_f32 v88, v88, v89
    v_cvt_pk_bf16_f32 v89, v90, v91
    v_cvt_pk_bf16_f32 v90, v92, v93
    v_cvt_pk_bf16_f32 v91, v94, v95
    s_add_u32 m0, s61, 158464
    s_add_u32 s61, s61, 114688
    buffer_load_dwordx4 v13, s[36:39], s61 offen sc1 lds
    v_exp_f32 v96, v96
    v_exp_f32 v97, v97
    s_waitcnt lgkmcnt(4)
    v_mfma_f32_32x32x16_bf16 v[208:223], v[50:53], v[72:75], v[208:223]
    ds_read_b64_tr_b16 v[50:51], v9 offset:512
    ds_read_b64_tr_b16 v[52:53], v9 offset:576
    v_exp_f32 v98, v98
    v_exp_f32 v99, v99
    v_exp_f32 v100, v100
    v_exp_f32 v101, v101
    v_exp_f32 v102, v102
    v_exp_f32 v103, v103
    v_cvt_pk_bf16_f32 v96, v96, v97
    v_cvt_pk_bf16_f32 v97, v98, v99
    v_cvt_pk_bf16_f32 v98, v100, v101
    v_cvt_pk_bf16_f32 v99, v102, v103
    v_exp_f32 v104, v104
    v_exp_f32 v105, v105
    s_waitcnt lgkmcnt(4)
    v_mfma_f32_32x32x16_bf16 v[208:223], v[54:57], v[80:83], v[208:223]
    ds_read_b64_tr_b16 v[54:55], v9 offset:640
    ds_read_b64_tr_b16 v[56:57], v9 offset:704
    v_exp_f32 v106, v106
    v_exp_f32 v107, v107
    v_exp_f32 v108, v108
    v_exp_f32 v109, v109
    v_mfma_f32_32x32x16_bf16 v[64:79], v[44:47], v[24:27], v[160:175]
    v_exp_f32 v110, v110
    v_exp_f32 v111, v111
    v_mfma_f32_32x32x8_bf16 v[64:79], v[48:49], v[28:29], v[64:79]
    v_cvt_pk_bf16_f32 v104, v104, v105
    v_cvt_pk_bf16_f32 v105, v106, v107
    v_cvt_pk_bf16_f32 v106, v108, v109
    v_cvt_pk_bf16_f32 v107, v110, v111
    v_exp_f32 v112, v112
    v_exp_f32 v113, v113
    s_waitcnt lgkmcnt(4)
    v_mfma_f32_32x32x16_bf16 v[208:223], v[58:61], v[88:91], v[208:223]
    ds_read_b64_tr_b16 v[58:59], v9 offset:256
    ds_read_b64_tr_b16 v[60:61], v9 offset:320
    v_exp_f32 v114, v114
    v_exp_f32 v115, v115
    v_exp_f32 v116, v116
    v_exp_f32 v117, v117
    v_exp_f32 v118, v118
    v_exp_f32 v119, v119
    v_cvt_pk_bf16_f32 v112, v112, v113
    v_cvt_pk_bf16_f32 v113, v114, v115
    v_cvt_pk_bf16_f32 v114, v116, v117
    v_cvt_pk_bf16_f32 v115, v118, v119
    v_exp_f32 v120, v120
    v_exp_f32 v121, v121
    s_waitcnt lgkmcnt(4)
    v_mfma_f32_32x32x16_bf16 v[208:223], v[50:53], v[96:99], v[208:223]
    ds_read_b64_tr_b16 v[50:51], v9 offset:384
    ds_read_b64_tr_b16 v[52:53], v9 offset:448
    v_exp_f32 v122, v122
    v_exp_f32 v123, v123
    v_exp_f32 v124, v124
    v_exp_f32 v125, v125
    v_exp_f32 v126, v126
    v_exp_f32 v127, v127
    v_cvt_pk_bf16_f32 v120, v120, v121
    v_cvt_pk_bf16_f32 v121, v122, v123
    v_cvt_pk_bf16_f32 v122, v124, v125
    v_cvt_pk_bf16_f32 v123, v126, v127
    v_exp_f32 v64, v64
    v_exp_f32 v65, v65
    s_waitcnt lgkmcnt(4)
    v_mfma_f32_32x32x16_bf16 v[208:223], v[54:57], v[104:107], v[208:223]
    ds_read_b64_tr_b16 v[54:55], v9 offset:0
    ds_read_b64_tr_b16 v[56:57], v9 offset:64
    v_exp_f32 v66, v66
    v_exp_f32 v67, v67
    v_exp_f32 v68, v68
    v_exp_f32 v69, v69
    v_exp_f32 v70, v70
    v_exp_f32 v71, v71
    v_cvt_pk_bf16_f32 v64, v64, v65
    v_cvt_pk_bf16_f32 v65, v66, v67
    v_cvt_pk_bf16_f32 v66, v68, v69
    v_cvt_pk_bf16_f32 v67, v70, v71
    v_exp_f32 v72, v72
    v_exp_f32 v73, v73
    s_waitcnt lgkmcnt(4)
    v_mfma_f32_32x32x16_bf16 v[208:223], v[58:61], v[112:115], v[208:223]
    ds_read_b64_tr_b16 v[58:59], v9 offset:128
    ds_read_b64_tr_b16 v[60:61], v9 offset:192
    v_exp_f32 v74, v74
    v_exp_f32 v75, v75
    v_exp_f32 v76, v76
    v_exp_f32 v77, v77
    v_exp_f32 v78, v78
    v_exp_f32 v79, v79
    v_cvt_pk_bf16_f32 v72, v72, v73
    v_cvt_pk_bf16_f32 v73, v74, v75
    v_cvt_pk_bf16_f32 v74, v76, v77
    v_cvt_pk_bf16_f32 v75, v78, v79
    s_waitcnt lgkmcnt(4)
    v_mfma_f32_32x32x16_bf16 v[208:223], v[50:53], v[120:123], v[208:223]
    s_waitcnt lgkmcnt(2)
    v_mfma_f32_32x32x16_bf16 v[208:223], v[54:57], v[64:67], v[208:223]
    s_waitcnt lgkmcnt(0)
    v_mfma_f32_32x32x16_bf16 v[208:223], v[58:61], v[72:75], v[208:223]
    v_mov_b32 v14, 0x30800000
    v_mov_b32 v15, 0x4e800000
    s_nop 9
    v_cmp_gt_f32 vcc, v221, v14
    v_cmp_lt_f32 s[4:5], v221, v15
    s_nop 0
    s_and_b64 vcc, vcc, s[4:5]
    s_cmp_eq_u64 vcc, -1
    s_cbranch_scc0 L_att_slow
L_att_done:
    v_rcp_f32 v7, v221
    s_nop 0
    v_mul_f32 v208, v7, v208
    v_mul_f32 v209, v7, v209
    v_mul_f32 v210, v7, v210
    v_mul_f32 v211, v7, v211
    v_mul_f32 v212, v7, v212
    v_mul_f32 v213, v7, v213
    v_mul_f32 v214, v7, v214
    v_mul_f32 v215, v7, v215
    v_mul_f32 v216, v7, v216
    v_mul_f32 v217, v7, v217
    v_mul_f32 v218, v7, v218
    v_mul_f32 v219, v7, v219
    v_cvt_pk_bf16_f32 v16, v208, v209
    v_cvt_pk_bf16_f32 v17, v210, v211
    v_cvt_pk_bf16_f32 v18, v212, v213
    v_cvt_pk_bf16_f32 v19, v214, v215
    v_cvt_pk_bf16_f32 v20, v216, v217
    v_cvt_pk_bf16_f32 v21, v218, v219
    buffer_store_dwordx4 v[16:19], v240, s[36:39], s90 offen sc1
    s_mov_b32 exec_hi, 0
    buffer_store_dwordx2 v[20:21], v241, s[36:39], s91 offen sc1
    s_mov_b64 exec, -1
    s_waitcnt vmcnt(0)
    v_mov_b32 v2, 163784
    v_mov_b32 v3, 1
    s_mov_b64 exec, 1
    ds_add_rtn_u32 v2, v2, v3
    s_waitcnt lgkmcnt(0)
    v_readfirstlane_b32 s3, v2
    s_nop 0
    s_cmp_eq_u32 s3, 7
    s_cbranch_scc0 Lsig_14
    s_mov_b32 exec_lo, -1
    buffer_atomic_add v3, v232, s[36:39], 0 offen sc1
    s_mov_b64 exec, 0xffff
    buffer_atomic_add v3, v233, s[36:39], 0 offen sc1
Lsig_14:
    s_mov_b64 exec, -1
    s_cmp_ge_u32 s44, 4
    s_cbranch_scc0 L_p3
    buffer_store_dwordx4 v[136:139], v155, s[36:39], 0 offen offset:0 sc1
    buffer_store_dwordx4 v[148:151], v159, s[36:39], 0 offen offset:0 sc1
    s_setprio 0
L_p3:
    s_cmp_ge_u32 s44, 4
    s_cbranch_scc1 L_helper
    s_lshr_b32 s57, s44, 1
    s_and_b32 s58, s44, 1
    s_mul_i32 s80, s44, 5120
    v_lshrrev_b32 v2, 4, v1
    v_bfe_u32 v3, v1, 2, 2
    v_and_b32 v12, 3, v1
    v_lshrrev_b32 v5, 5, v1
    v_mul_u32_u24 v5, 20, v5
    v_bfe_u32 v6, v1, 4, 1
    v_lshl_add_u32 v5, v6, 2, v5
    v_add_u32 v5, v5, v3
    v_mul_u32_u24 v6, 20, v2
    v_add3_u32 v6, v6, v3, 16
    s_mul_i32 s3, s58, 51200
    s_add_u32 s3, s3, 55296
    v_mul_u32_u24 v8, 160, v5
    v_lshl_add_u32 v8, v12, 3, v8
    v_add_u32 v8, s3, v8
    v_mul_u32_u24 v9, 160, v6
    v_lshl_add_u32 v9, v12, 3, v9
    v_add_u32 v9, s3, v9
    s_mul_i32 s3, s58, 2560
    s_add_u32 s3, s3, 158464
    v_lshlrev_b32 v10, 3, v5
    v_add_u32 v10, s3, v10
    v_lshlrev_b32 v11, 3, v6
    v_add_u32 v11, s3, v11
    v_lshlrev_b32 v7, 4, v1
    v_lshlrev_b32 v4, 3, v1
    s_lshl_b32 s59, s52, 2
    s_add_u32 s59, s59, s44
    v_and_b32 v14, 15, v1
    v_mul_u32_u24 v15, 1280, v14
    v_lshl_add_u32 v15, v2, 3, v15
    s_mul_i32 s60, s59, 20480
    s_mul_i32 s3, s53, 160
    s_add_u32 s60, s60, s3
    s_lshl_b32 s62, s59, 14
    s_lshl_b32 s4, s58, 13
    s_add_u32 s62, s62, s4
    s_add_u32 s62, s62, 9437184
    s_xor_b32 s63, s62, 16384
    s_add_u32 s64, s62, 4096
    s_add_u32 s65, s63, 4096
    s_lshl_b32 s66, s59, 12
    s_lshl_b32 s5, s58, 11
    s_add_u32 s66, s66, s5
    s_add_u32 s66, s66, 11534336
    s_xor_b32 s67, s66, 4096
    s_lshl_b32 s68, s59, 7
    s_add_u32 s68, s68, 65536
    v_lshlrev_b32 v19, 3, v14
    s_mov_b32 s92, 0
L_p3_re:
    buffer_load_dwordx2 v[72:73], v15, s[8:11], s60 offen offset:0
    buffer_load_dwordx2 v[74:75], v15, s[8:11], s60 offen offset:32
    buffer_load_dwordx2 v[76:77], v15, s[8:11], s60 offen offset:64
    buffer_load_dwordx2 v[78:79], v15, s[8:11], s60 offen offset:96
    buffer_load_dwordx2 v[80:81], v15, s[8:11], s60 offen offset:128
    buffer_load_dword v82, v19, s[36:39], s68 offen sc1
    s_mul_i32 s3, s44, 5632
    s_add_u32 s3, s3, 20480
    v_add_u32 v16, s3, v7
    v_add_u32 v12, s3, v4
    s_xor_b32 s3, s44, 1
    s_mul_i32 s3, s3, 5632
    s_add_u32 s3, s3, 20480
    v_add_u32 v17, s3, v7
    v_add_u32 v13, s3, v4
    s_mul_i32 s3, s59, 20480
    s_add_u32 s3, s3, 12582912
    s_lshl_b32 s4, s53, 11
    s_add_u32 s83, s3, s4
    s_lshl_b32 s5, s53, 9
    s_add_u32 s84, s3, s5
    s_add_u32 s84, s84, 16384
    v_lshrrev_b32 v2, 5, v1
    v_lshlrev_b32 v23, 8, v2
    v_lshl_add_u32 v23, v14, 4, v23
    v_bfe_u32 v2, v1, 4, 1
    v_lshl_add_u32 v23, v2, 3, v23
    s_lshl_b32 s3, s59, 9
    s_lshl_b32 s4, s53, 2
    s_add_u32 s3, s3, s4
    s_add_u32 s85, s3, 131072
    v_lshlrev_b32 v22, 5, v14
    v_mov_b32 v2, 163784
    s_mov_b32 s3, 0
Llw_15:
    s_sleep 1
    ds_read_b32 v3, v2
    s_add_u32 s3, s3, 1
    s_waitcnt lgkmcnt(0)
    v_readfirstlane_b32 s4, v3
    s_cmp_gt_u32 s3, 2097152
    s_cbranch_scc1 Llwx_16
    s_cmp_lt_u32 s4, 8
    s_cbranch_scc1 Llw_15
Llwx_16:
    ds_read_b64_tr_b16 v[152:153], v8 offset:0
    ds_read_b64_tr_b16 v[154:155], v8 offset:1280
    ds_read_b64_tr_b16 v[156:157], v8 offset:32
    ds_read_b64_tr_b16 v[158:159], v8 offset:1312
    ds_read_b64_tr_b16 v[160:161], v8 offset:64
    ds_read_b64_tr_b16 v[162:163], v8 offset:1344
    ds_read_b64_tr_b16 v[164:165], v8 offset:96
    ds_read_b64_tr_b16 v[166:167], v8 offset:1376
    ds_read_b64_tr_b16 v[168:169], v8 offset:128
    ds_read_b64_tr_b16 v[170:171], v8 offset:1408
    ds_read_b64_tr_b16 v[172:173], v10 offset:0
    ds_read_b64_tr_b16 v[174:175], v10 offset:64
    ds_read_b64_tr_b16 v[176:177], v8 offset:6400
    ds_read_b64_tr_b16 v[178:179], v8 offset:7680
    ds_read_b64_tr_b16 v[180:181], v8 offset:6432
    ds_read_b64_tr_b16 v[182:183], v8 offset:7712
    ds_read_b64_tr_b16 v[184:185], v8 offset:6464
    ds_read_b64_tr_b16 v[186:187], v8 offset:7744
    ds_read_b64_tr_b16 v[188:189], v8 offset:6496
    ds_read_b64_tr_b16 v[190:191], v8 offset:7776
    ds_read_b64_tr_b16 v[192:193], v8 offset:6528
    ds_read_b64_tr_b16 v[194:195], v8 offset:7808
    ds_read_b64_tr_b16 v[196:197], v10 offset:320
    ds_read_b64_tr_b16 v[198:199], v10 offset:384
    ds_read_b64_tr_b16 v[200:201], v8 offset:12800
    ds_read_b64_tr_b16 v[202:203], v8 offset:14080
    ds_read_b64_tr_b16 v[204:205], v8 offset:12832
    ds_read_b64_tr_b16 v[206:207], v8 offset:14112
    ds_read_b64_tr_b16 v[208:209], v8 offset:12864
    ds_read_b64_tr_b16 v[210:211], v8 offset:14144
    ds_read_b64_tr_b16 v[212:213], v8 offset:12896
    ds_read_b64_tr_b16 v[214:215], v8 offset:14176
    ds_read_b64_tr_b16 v[216:217], v8 offset:12928
    ds_read_b64_tr_b16 v[218:219], v8 offset:14208
    ds_read_b64_tr_b16 v[220:221], v10 offset:640
    ds_read_b64_tr_b16 v[222:223], v10 offset:704
    ds_read_b64_tr_b16 v[224:225], v8 offset:19200
    ds_read_b64_tr_b16 v[226:227], v8 offset:20480
    ds_read_b64_tr_b16 v[228:229], v8 offset:19232
    ds_read_b64_tr_b16 v[230:231], v8 offset:20512
    ds_read_b64_tr_b16 v[232:233], v8 offset:19264
    ds_read_b64_tr_b16 v[234:235], v8 offset:20544
    ds_read_b64_tr_b16 v[236:237], v8 offset:19296
    ds_read_b64_tr_b16 v[238:239], v8 offset:20576
    ds_read_b64_tr_b16 v[240:241], v8 offset:19328
    ds_read_b64_tr_b16 v[242:243], v8 offset:20608
    ds_read_b64_tr_b16 v[244:245], v10 offset:960
    ds_read_b64_tr_b16 v[246:247], v10 offset:1024
    s_waitcnt vmcnt(0)
    v_lshlrev_b32 v24, 16, v72
    v_and_b32 v25, 0xffff0000, v72
    v_lshlrev_b32 v26, 16, v73
    v_and_b32 v27, 0xffff0000, v73
    v_lshlrev_b32 v28, 16, v74
    v_and_b32 v29, 0xffff0000, v74
    v_lshlrev_b32 v30, 16, v75
    v_and_b32 v31, 0xffff0000, v75
    v_lshlrev_b32 v32, 16, v76
    v_and_b32 v33, 0xffff0000, v76
    v_lshlrev_b32 v34, 16, v77
    v_and_b32 v35, 0xffff0000, v77
    v_lshlrev_b32 v36, 16, v78
    v_and_b32 v37, 0xffff0000, v78
    v_lshlrev_b32 v38, 16, v79
    v_and_b32 v39, 0xffff0000, v79
    v_lshlrev_b32 v40, 16, v80
    v_and_b32 v41, 0xffff0000, v80
    v_lshlrev_b32 v42, 16, v81
    v_and_b32 v43, 0xffff0000, v81
    v_lshlrev_b32 v44, 16, v82
    v_and_b32 v45, 0xffff0000, v82
    v_mov_b32 v250, 0
    s_waitcnt lgkmcnt(0)
    s_barrier
    buffer_load_dwordx4 v[72:75], v7, s[36:39], s62 offen offset:0 sc1
    buffer_load_dwordx4 v[76:79], v7, s[36:39], s63 offen offset:0 sc1
    buffer_load_dwordx4 v[80:83], v7, s[36:39], s62 offen offset:1024 sc1
    buffer_load_dwordx4 v[84:87], v7, s[36:39], s63 offen offset:1024 sc1
    buffer_load_dwordx4 v[88:91], v7, s[36:39], s62 offen offset:2048 sc1
    buffer_load_dwordx4 v[92:95], v7, s[36:39], s63 offen offset:2048 sc1
    buffer_load_dwordx4 v[96:99], v7, s[36:39], s62 offen offset:3072 sc1
    buffer_load_dwordx4 v[100:103], v7, s[36:39], s63 offen offset:3072 sc1
    buffer_load_dwordx4 v[104:107], v7, s[36:39], s64 offen offset:0 sc1
    buffer_load_dwordx4 v[108:111], v7, s[36:39], s65 offen offset:0 sc1
    s_waitcnt vmcnt(8)
    v_mfma_f32_16x16x32_bf16 v[24:27], v[152:155], v[72:75], v[24:27]
    v_mfma_f32_16x16x32_bf16 v[48:51], v[152:155], v[76:79], 0
    buffer_load_dwordx4 v[112:115], v7, s[36:39], s64 offen offset:1024 sc1
    buffer_load_dwordx4 v[116:119], v7, s[36:39], s65 offen offset:1024 sc1
    v_mfma_f32_16x16x32_bf16 v[28:31], v[156:159], v[72:75], v[28:31]
    ds_read_b64_tr_b16 v[152:153], v8 offset:25600
    v_mfma_f32_16x16x32_bf16 v[52:55], v[156:159], v[76:79], 0
    ds_read_b64_tr_b16 v[154:155], v8 offset:26880
    v_mfma_f32_16x16x32_bf16 v[32:35], v[160:163], v[72:75], v[32:35]
    ds_read_b64_tr_b16 v[156:157], v8 offset:25632
    v_mfma_f32_16x16x32_bf16 v[56:59], v[160:163], v[76:79], 0
    ds_read_b64_tr_b16 v[158:159], v8 offset:26912
    v_mfma_f32_16x16x32_bf16 v[36:39], v[164:167], v[72:75], v[36:39]
    ds_read_b64_tr_b16 v[160:161], v8 offset:25664
    v_mfma_f32_16x16x32_bf16 v[60:63], v[164:167], v[76:79], 0
    ds_read_b64_tr_b16 v[162:163], v8 offset:26944
    v_mfma_f32_16x16x32_bf16 v[40:43], v[168:171], v[72:75], v[40:43]
    ds_read_b64_tr_b16 v[164:165], v8 offset:25696
    v_mfma_f32_16x16x32_bf16 v[64:67], v[168:171], v[76:79], 0
    ds_read_b64_tr_b16 v[166:167], v8 offset:26976
    v_mfma_f32_16x16x32_bf16 v[44:47], v[172:175], v[72:75], v[44:47]
    ds_read_b64_tr_b16 v[168:169], v8 offset:25728
    v_mfma_f32_16x16x32_bf16 v[68:71], v[172:175], v[76:79], 0
    ds_read_b64_tr_b16 v[170:171], v8 offset:27008
    s_waitcnt vmcnt(8)
    v_mfma_f32_16x16x32_bf16 v[24:27], v[176:179], v[80:83], v[24:27]
    ds_read_b64_tr_b16 v[172:173], v10 offset:1280
    v_mfma_f32_16x16x32_bf16 v[48:51], v[176:179], v[84:87], v[48:51]
    ds_read_b64_tr_b16 v[174:175], v10 offset:1344
    buffer_load_dwordx4 v[120:123], v7, s[36:39], s64 offen offset:2048 sc1
    buffer_load_dwordx4 v[124:127], v7, s[36:39], s65 offen offset:2048 sc1
    v_mfma_f32_16x16x32_bf16 v[28:31], v[180:183], v[80:83], v[28:31]
    ds_read_b64_tr_b16 v[176:177], v8 offset:32000
    v_mfma_f32_16x16x32_bf16 v[52:55], v[180:183], v[84:87], v[52:55]
    ds_read_b64_tr_b16 v[178:179], v8 offset:33280
    v_mfma_f32_16x16x32_bf16 v[32:35], v[184:187], v[80:83], v[32:35]
    ds_read_b64_tr_b16 v[180:181], v8 offset:32032
    v_mfma_f32_16x16x32_bf16 v[56:59], v[184:187], v[84:87], v[56:59]
    ds_read_b64_tr_b16 v[182:183], v8 offset:33312
    v_mfma_f32_16x16x32_bf16 v[36:39], v[188:191], v[80:83], v[36:39]
    ds_read_b64_tr_b16 v[184:185], v8 offset:32064
    v_mfma_f32_16x16x32_bf16 v[60:63], v[188:191], v[84:87], v[60:63]
    ds_read_b64_tr_b16 v[186:187], v8 offset:33344
    v_mfma_f32_16x16x32_bf16 v[40:43], v[192:195], v[80:83], v[40:43]
    ds_read_b64_tr_b16 v[188:189], v8 offset:32096
    v_mfma_f32_16x16x32_bf16 v[64:67], v[192:195], v[84:87], v[64:67]
    ds_read_b64_tr_b16 v[190:191], v8 offset:33376
    v_mfma_f32_16x16x32_bf16 v[44:47], v[196:199], v[80:83], v[44:47]
    ds_read_b64_tr_b16 v[192:193], v8 offset:32128
    v_mfma_f32_16x16x32_bf16 v[68:71], v[196:199], v[84:87], v[68:71]
    ds_read_b64_tr_b16 v[194:195], v8 offset:33408
    s_waitcnt vmcnt(8)
    v_mfma_f32_16x16x32_bf16 v[24:27], v[200:203], v[88:91], v[24:27]
    ds_read_b64_tr_b16 v[196:197], v10 offset:1600
    v_mfma_f32_16x16x32_bf16 v[48:51], v[200:203], v[92:95], v[48:51]
    ds_read_b64_tr_b16 v[198:199], v10 offset:1664
    buffer_load_dwordx4 v[128:131], v7, s[36:39], s64 offen offset:3072 sc1
    buffer_load_dwordx4 v[132:135], v7, s[36:39], s65 offen offset:3072 sc1
    v_mfma_f32_16x16x32_bf16 v[28:31], v[204:207], v[88:91], v[28:31]
    ds_read_b64_tr_b16 v[200:201], v8 offset:38400
    v_mfma_f32_16x16x32_bf16 v[52:55], v[204:207], v[92:95], v[52:55]
    ds_read_b64_tr_b16 v[202:203], v8 offset:39680
    v_mfma_f32_16x16x32_bf16 v[32:35], v[208:211], v[88:91], v[32:35]
    ds_read_b64_tr_b16 v[204:205], v8 offset:38432
    v_mfma_f32_16x16x32_bf16 v[56:59], v[208:211], v[92:95], v[56:59]
    ds_read_b64_tr_b16 v[206:207], v8 offset:39712
    v_mfma_f32_16x16x32_bf16 v[36:39], v[212:215], v[88:91], v[36:39]
    ds_read_b64_tr_b16 v[208:209], v8 offset:38464
    v_mfma_f32_16x16x32_bf16 v[60:63], v[212:215], v[92:95], v[60:63]
    ds_read_b64_tr_b16 v[210:211], v8 offset:39744
    v_mfma_f32_16x16x32_bf16 v[40:43], v[216:219], v[88:91], v[40:43]
    ds_read_b64_tr_b16 v[212:213], v8 offset:38496
    v_mfma_f32_16x16x32_bf16 v[64:67], v[216:219], v[92:95], v[64:67]
    ds_read_b64_tr_b16 v[214:215], v8 offset:39776
    v_mfma_f32_16x16x32_bf16 v[44:47], v[220:223], v[88:91], v[44:47]
    ds_read_b64_tr_b16 v[216:217], v8 offset:38528
    v_mfma_f32_16x16x32_bf16 v[68:71], v[220:223], v[92:95], v[68:71]
    ds_read_b64_tr_b16 v[218:219], v8 offset:39808
    s_waitcnt vmcnt(8)
    v_mfma_f32_16x16x32_bf16 v[24:27], v[224:227], v[96:99], v[24:27]
    ds_read_b64_tr_b16 v[220:221], v10 offset:1920
    v_mfma_f32_16x16x32_bf16 v[48:51], v[224:227], v[100:103], v[48:51]
    ds_read_b64_tr_b16 v[222:223], v10 offset:1984
    buffer_load_dwordx2 v[136:137], v4, s[36:39], s66 offen offset:0 sc1
    buffer_load_dwordx2 v[138:139], v4, s[36:39], s66 offen offset:512 sc1
    buffer_load_dwordx2 v[140:141], v4, s[36:39], s67 offen offset:0 sc1
    buffer_load_dwordx2 v[142:143], v4, s[36:39], s67 offen offset:512 sc1
    v_mfma_f32_16x16x32_bf16 v[28:31], v[228:231], v[96:99], v[28:31]
    ds_read_b64_tr_b16 v[224:225], v8 offset:44800
    v_mfma_f32_16x16x32_bf16 v[52:55], v[228:231], v[100:103], v[52:55]
    ds_read_b64_tr_b16 v[226:227], v8 offset:46080
    v_mfma_f32_16x16x32_bf16 v[32:35], v[232:235], v[96:99], v[32:35]
    ds_read_b64_tr_b16 v[228:229], v8 offset:44832
    v_mfma_f32_16x16x32_bf16 v[56:59], v[232:235], v[100:103], v[56:59]
    ds_read_b64_tr_b16 v[230:231], v8 offset:46112
    v_mfma_f32_16x16x32_bf16 v[36:39], v[236:239], v[96:99], v[36:39]
    ds_read_b64_tr_b16 v[232:233], v8 offset:44864
    v_mfma_f32_16x16x32_bf16 v[60:63], v[236:239], v[100:103], v[60:63]
    ds_read_b64_tr_b16 v[234:235], v8 offset:46144
    v_mfma_f32_16x16x32_bf16 v[40:43], v[240:243], v[96:99], v[40:43]
    ds_read_b64_tr_b16 v[236:237], v8 offset:44896
    v_mfma_f32_16x16x32_bf16 v[64:67], v[240:243], v[100:103], v[64:67]
    ds_read_b64_tr_b16 v[238:239], v8 offset:46176
    v_mfma_f32_16x16x32_bf16 v[44:47], v[244:247], v[96:99], v[44:47]
    ds_read_b64_tr_b16 v[240:241], v8 offset:44928
    v_mfma_f32_16x16x32_bf16 v[68:71], v[244:247], v[100:103], v[68:71]
    ds_read_b64_tr_b16 v[242:243], v8 offset:46208
    s_waitcnt vmcnt(10)
    s_waitcnt lgkmcnt(15)
    v_mfma_f32_16x16x32_bf16 v[24:27], v[152:155], v[104:107], v[24:27]
    ds_read_b64_tr_b16 v[244:245], v10 offset:2240
    v_mfma_f32_16x16x32_bf16 v[48:51], v[152:155], v[108:111], v[48:51]
    ds_read_b64_tr_b16 v[246:247], v10 offset:2304
    buffer_load_dwordx2 v[144:145], v4, s[36:39], s66 offen offset:1024 sc1
    buffer_load_dwordx2 v[146:147], v4, s[36:39], s66 offen offset:1536 sc1
    buffer_load_dwordx2 v[148:149], v4, s[36:39], s67 offen offset:1024 sc1
    buffer_load_dwordx2 v[150:151], v4, s[36:39], s67 offen offset:1536 sc1
    v_mfma_f32_16x16x32_bf16 v[28:31], v[156:159], v[104:107], v[28:31]
    ds_read_b64_tr_b16 v[152:153], v9 offset:0
    v_mfma_f32_16x16x32_bf16 v[52:55], v[156:159], v[108:111], v[52:55]
    ds_read_b64_tr_b16 v[154:155], v9 offset:12800
    s_barrier
    v_mfma_f32_16x16x32_bf16 v[32:35], v[160:163], v[104:107], v[32:35]
    ds_read_b64_tr_b16 v[156:157], v9 offset:32
    v_mfma_f32_16x16x32_bf16 v[56:59], v[160:163], v[108:111], v[56:59]
    ds_read_b64_tr_b16 v[158:159], v9 offset:12832
    v_mfma_f32_16x16x32_bf16 v[36:39], v[164:167], v[104:107], v[36:39]
    ds_read_b64_tr_b16 v[160:161], v9 offset:64
    v_mfma_f32_16x16x32_bf16 v[60:63], v[164:167], v[108:111], v[60:63]
    ds_read_b64_tr_b16 v[162:163], v9 offset:12864
    v_mfma_f32_16x16x32_bf16 v[40:43], v[168:171], v[104:107], v[40:43]
    ds_read_b64_tr_b16 v[164:165], v9 offset:96
    v_mfma_f32_16x16x32_bf16 v[64:67], v[168:171], v[108:111], v[64:67]
    ds_read_b64_tr_b16 v[166:167], v9 offset:12896
    v_mfma_f32_16x16x32_bf16 v[44:47], v[172:175], v[104:107], v[44:47]
    ds_read_b64_tr_b16 v[168:169], v9 offset:128
    v_mfma_f32_16x16x32_bf16 v[68:71], v[172:175], v[108:111], v[68:71]
    ds_read_b64_tr_b16 v[170:171], v9 offset:12928
    s_waitcnt vmcnt(12)
    v_mfma_f32_16x16x32_bf16 v[24:27], v[176:179], v[112:115], v[24:27]
    ds_read_b64_tr_b16 v[172:173], v11 offset:0
    v_mfma_f32_16x16x32_bf16 v[48:51], v[176:179], v[116:119], v[48:51]
    ds_read_b64_tr_b16 v[174:175], v11 offset:640
    v_mfma_f32_16x16x32_bf16 v[28:31], v[180:183], v[112:115], v[28:31]
    ds_read_b64_tr_b16 v[176:177], v9 offset:25600
    v_mfma_f32_16x16x32_bf16 v[52:55], v[180:183], v[116:119], v[52:55]
    ds_read_b64_tr_b16 v[178:179], v9 offset:38400
    v_mfma_f32_16x16x32_bf16 v[32:35], v[184:187], v[112:115], v[32:35]
    ds_read_b64_tr_b16 v[180:181], v9 offset:25632
    v_mfma_f32_16x16x32_bf16 v[56:59], v[184:187], v[116:119], v[56:59]
    ds_read_b64_tr_b16 v[182:183], v9 offset:38432
    v_mfma_f32_16x16x32_bf16 v[36:39], v[188:191], v[112:115], v[36:39]
    ds_read_b64_tr_b16 v[184:185], v9 offset:25664
    v_mfma_f32_16x16x32_bf16 v[60:63], v[188:191], v[116:119], v[60:63]
    ds_read_b64_tr_b16 v[186:187], v9 offset:38464
    v_mfma_f32_16x16x32_bf16 v[40:43], v[192:195], v[112:115], v[40:43]
    ds_read_b64_tr_b16 v[188:189], v9 offset:25696
    v_mfma_f32_16x16x32_bf16 v[64:67], v[192:195], v[116:119], v[64:67]
    ds_read_b64_tr_b16 v[190:191], v9 offset:38496
    v_mfma_f32_16x16x32_bf16 v[44:47], v[196:199], v[112:115], v[44:47]
    ds_read_b64_tr_b16 v[192:193], v9 offset:25728
    v_mfma_f32_16x16x32_bf16 v[68:71], v[196:199], v[116:119], v[68:71]
    ds_read_b64_tr_b16 v[194:195], v9 offset:38528
    s_waitcnt vmcnt(10)
    v_mfma_f32_16x16x32_bf16 v[24:27], v[200:203], v[120:123], v[24:27]
    ds_read_b64_tr_b16 v[196:197], v11 offset:1280
    v_mfma_f32_16x16x32_bf16 v[48:51], v[200:203], v[124:127], v[48:51]
    ds_read_b64_tr_b16 v[198:199], v11 offset:1920
    v_mfma_f32_16x16x32_bf16 v[28:31], v[204:207], v[120:123], v[28:31]
    v_mfma_f32_16x16x32_bf16 v[52:55], v[204:207], v[124:127], v[52:55]
    v_mfma_f32_16x16x32_bf16 v[32:35], v[208:211], v[120:123], v[32:35]
    v_mfma_f32_16x16x32_bf16 v[56:59], v[208:211], v[124:127], v[56:59]
    s_waitcnt lgkmcnt(15)
    v_mfma_f32_16x16x32_bf16 v[36:39], v[212:215], v[120:123], v[36:39]
    v_mfma_f32_16x16x32_bf16 v[60:63], v[212:215], v[124:127], v[60:63]
    v_mfma_f32_16x16x32_bf16 v[40:43], v[216:219], v[120:123], v[40:43]
    v_mfma_f32_16x16x32_bf16 v[64:67], v[216:219], v[124:127], v[64:67]
    v_mfma_f32_16x16x32_bf16 v[44:47], v[220:223], v[120:123], v[44:47]
    v_mfma_f32_16x16x32_bf16 v[68:71], v[220:223], v[124:127], v[68:71]
    s_waitcnt vmcnt(8)
    v_mfma_f32_16x16x32_bf16 v[24:27], v[224:227], v[128:131], v[24:27]
    v_mfma_f32_16x16x32_bf16 v[48:51], v[224:227], v[132:135], v[48:51]
    v_mfma_f32_16x16x32_bf16 v[28:31], v[228:231], v[128:131], v[28:31]
    v_mfma_f32_16x16x32_bf16 v[52:55], v[228:231], v[132:135], v[52:55]
    v_mfma_f32_16x16x32_bf16 v[32:35], v[232:235], v[128:131], v[32:35]
    v_mfma_f32_16x16x32_bf16 v[56:59], v[232:235], v[132:135], v[56:59]
    v_mfma_f32_16x16x32_bf16 v[36:39], v[236:239], v[128:131], v[36:39]
    v_mfma_f32_16x16x32_bf16 v[60:63], v[236:239], v[132:135], v[60:63]
    v_mfma_f32_16x16x32_bf16 v[40:43], v[240:243], v[128:131], v[40:43]
    v_mfma_f32_16x16x32_bf16 v[64:67], v[240:243], v[132:135], v[64:67]
    v_mfma_f32_16x16x32_bf16 v[44:47], v[244:247], v[128:131], v[44:47]
    v_mfma_f32_16x16x32_bf16 v[68:71], v[244:247], v[132:135], v[68:71]
    s_waitcnt vmcnt(4)
    v_mfma_f32_16x16x32_bf16 v[24:27], v[152:155], v[136:139], v[24:27]
    v_mfma_f32_16x16x32_bf16 v[48:51], v[152:155], v[140:143], v[48:51]
    v_mfma_f32_16x16x32_bf16 v[28:31], v[156:159], v[136:139], v[28:31]
    v_mfma_f32_16x16x32_bf16 v[52:55], v[156:159], v[140:143], v[52:55]
    v_mfma_f32_16x16x32_bf16 v[32:35], v[160:163], v[136:139], v[32:35]
    v_mfma_f32_16x16x32_bf16 v[56:59], v[160:163], v[140:143], v[56:59]
    v_mfma_f32_16x16x32_bf16 v[36:39], v[164:167], v[136:139], v[36:39]
    v_mfma_f32_16x16x32_bf16 v[60:63], v[164:167], v[140:143], v[60:63]
    s_waitcnt lgkmcnt(14)
    v_mfma_f32_16x16x32_bf16 v[40:43], v[168:171], v[136:139], v[40:43]
    v_mfma_f32_16x16x32_bf16 v[64:67], v[168:171], v[140:143], v[64:67]
    s_waitcnt lgkmcnt(12)
    v_mfma_f32_16x16x32_bf16 v[44:47], v[172:175], v[136:139], v[44:47]
    v_mfma_f32_16x16x32_bf16 v[68:71], v[172:175], v[140:143], v[68:71]
    s_waitcnt vmcnt(0)
    s_waitcnt lgkmcnt(10)
    v_mfma_f32_16x16x32_bf16 v[24:27], v[176:179], v[144:147], v[24:27]
    v_mfma_f32_16x16x32_bf16 v[48:51], v[176:179], v[148:151], v[48:51]
    s_waitcnt lgkmcnt(8)
    v_mfma_f32_16x16x32_bf16 v[28:31], v[180:183], v[144:147], v[28:31]
    v_mfma_f32_16x16x32_bf16 v[52:55], v[180:183], v[148:151], v[52:55]
    s_waitcnt lgkmcnt(6)
    v_mfma_f32_16x16x32_bf16 v[32:35], v[184:187], v[144:147], v[32:35]
    v_mfma_f32_16x16x32_bf16 v[56:59], v[184:187], v[148:151], v[56:59]
    s_waitcnt lgkmcnt(4)
    v_mfma_f32_16x16x32_bf16 v[36:39], v[188:191], v[144:147], v[36:39]
    v_mfma_f32_16x16x32_bf16 v[60:63], v[188:191], v[148:151], v[60:63]
    s_waitcnt lgkmcnt(2)
    v_mfma_f32_16x16x32_bf16 v[40:43], v[192:195], v[144:147], v[40:43]
    v_mfma_f32_16x16x32_bf16 v[64:67], v[192:195], v[148:151], v[64:67]
    s_waitcnt lgkmcnt(0)
    v_mfma_f32_16x16x32_bf16 v[44:47], v[196:199], v[144:147], v[44:47]
    v_mfma_f32_16x16x32_bf16 v[68:71], v[196:199], v[148:151], v[68:71]
    s_nop 7
    ds_write_b64 v12, v[68:69] offset:5120
    ds_write_b128 v16, v[48:51] offset:0
    ds_write_b128 v16, v[52:55] offset:1024
    ds_write_b128 v16, v[56:59] offset:2048
    ds_write_b128 v16, v[60:63] offset:3072
    ds_write_b128 v16, v[64:67] offset:4096
    v_add_f32 v18, v44, v45
    v_mov_b32 v20, 0
    s_waitcnt lgkmcnt(0)
    s_barrier
    ds_read_b64 v[172:173], v13 offset:5120
    ds_read_b128 v[152:155], v17 offset:0
    ds_read_b128 v[156:159], v17 offset:1024
    ds_read_b128 v[160:163], v17 offset:2048
    ds_read_b128 v[164:167], v17 offset:3072
    ds_read_b128 v[168:171], v17 offset:4096
    s_waitcnt lgkmcnt(5)
    v_add_f32 v19, v172, v173
    v_add_f32 v18, v18, v19
    s_waitcnt lgkmcnt(4)
    v_add_f32 v24, v24, v152
    v_add_f32 v25, v25, v153
    v_add_f32 v26, v26, v154
    v_add_f32 v27, v27, v155
    v_add_f32 v152, v24, v18
    v_add_f32 v153, v25, v18
    v_add_f32 v154, v26, v18
    v_add_f32 v155, v27, v18
    v_cvt_pk_bf16_f32 v96, v152, v153
    v_cvt_pk_bf16_f32 v97, v154, v155
    s_waitcnt lgkmcnt(3)
    v_add_f32 v28, v28, v156
    v_add_f32 v29, v29, v157
    v_add_f32 v30, v30, v158
    v_add_f32 v31, v31, v159
    v_add_f32 v156, v28, v18
    v_add_f32 v157, v29, v18
    v_add_f32 v158, v30, v18
    v_add_f32 v159, v31, v18
    v_cvt_pk_bf16_f32 v98, v156, v157
    v_cvt_pk_bf16_f32 v99, v158, v159
    buffer_store_dwordx4 v[96:99], v7, s[36:39], s83 offen offset:0 sc1
    s_waitcnt lgkmcnt(2)
    v_add_f32 v32, v32, v160
    v_add_f32 v33, v33, v161
    v_add_f32 v34, v34, v162
    v_add_f32 v35, v35, v163
    v_add_f32 v160, v32, v18
    v_add_f32 v161, v33, v18
    v_add_f32 v162, v34, v18
    v_add_f32 v163, v35, v18
    v_cvt_pk_bf16_f32 v100, v160, v161
    v_cvt_pk_bf16_f32 v101, v162, v163
    s_waitcnt lgkmcnt(1)
    v_add_f32 v36, v36, v164
    v_add_f32 v37, v37, v165
    v_add_f32 v38, v38, v166
    v_add_f32 v39, v39, v167
    v_add_f32 v164, v36, v18
    v_add_f32 v165, v37, v18
    v_add_f32 v166, v38, v18
    v_add_f32 v167, v39, v18
    v_cvt_pk_bf16_f32 v102, v164, v165
    v_cvt_pk_bf16_f32 v103, v166, v167
    buffer_store_dwordx4 v[100:103], v7, s[36:39], s83 offen offset:1024 sc1
    s_waitcnt lgkmcnt(0)
    v_add_f32 v40, v40, v168
    v_add_f32 v41, v41, v169
    v_add_f32 v42, v42, v170
    v_add_f32 v43, v43, v171
    v_add_f32 v168, v40, v18
    v_add_f32 v169, v41, v18
    v_add_f32 v170, v42, v18
    v_add_f32 v171, v43, v18
    v_cvt_pk_bf16_f32 v104, v168, v169
    v_cvt_pk_bf16_f32 v105, v170, v171
    buffer_store_dwordx2 v[104:105], v23, s[36:39], s84 offen sc1
    s_barrier
    v_fmac_f32 v20, v152, v152
    v_fmac_f32 v20, v153, v153
    v_fmac_f32 v20, v154, v154
    v_fmac_f32 v20, v155, v155
    v_fmac_f32 v20, v156, v156
    v_fmac_f32 v20, v157, v157
    v_fmac_f32 v20, v158, v158
    v_fmac_f32 v20, v159, v159
    v_fmac_f32 v20, v160, v160
    v_fmac_f32 v20, v161, v161
    v_fmac_f32 v20, v162, v162
    v_fmac_f32 v20, v163, v163
    v_fmac_f32 v20, v164, v164
    v_fmac_f32 v20, v165, v165
    v_fmac_f32 v20, v166, v166
    v_fmac_f32 v20, v167, v167
    v_fmac_f32 v20, v168, v168
    v_fmac_f32 v20, v169, v169
    v_fmac_f32 v20, v170, v170
    v_fmac_f32 v20, v171, v171
    v_mov_b32 v21, v20
    s_nop 1
    v_permlane32_swap_b32 v20, v21
    v_add_f32 v20, v20, v21
    v_mov_b32 v21, v20
    s_nop 1
    v_permlane16_swap_b32 v20, v21
    v_add_f32 v20, v20, v21
    s_mov_b64 exec, 0xffff
    buffer_store_dword v20, v22, s[36:39], s85 offen sc1
    s_mov_b64 exec, -1
    v_cvt_pk_bf16_f32 v240, v24, v25
    v_cvt_pk_bf16_f32 v241, v26, v27
    v_cvt_pk_bf16_f32 v242, v28, v29
    v_cvt_pk_bf16_f32 v243, v30, v31
    v_cvt_pk_bf16_f32 v244, v32, v33
    v_cvt_pk_bf16_f32 v245, v34, v35
    v_cvt_pk_bf16_f32 v246, v36, v37
    v_cvt_pk_bf16_f32 v247, v38, v39
    v_cvt_pk_bf16_f32 v248, v40, v41
    v_cvt_pk_bf16_f32 v249, v42, v43
    s_mul_i32 s3, s44, 2560
    s_add_u32 s82, s3, 45056
    v_add_u32 v16, s82, v4
    ds_write_b64 v16, v[240:241] offset:0
    ds_write_b64 v16, v[242:243] offset:512
    ds_write_b64 v16, v[244:245] offset:1024
    ds_write_b64 v16, v[246:247] offset:1536
    ds_write_b64 v16, v[248:249] offset:2048
    v_add_u32 v5, 57344, v4
    v_add_u32 v6, 114688, v4
    s_lshl_b32 s3, s44, 12
    v_add_u32 v252, s3, v7
    v_add_u32 v253, 57344, v252
    v_add_u32 v254, 114688, v252
    s_lshl_b32 s61, s94, 3
    s_lshl_b32 s3, s44, 1
    s_add_u32 s61, s61, s3
    s_mul_i32 s66, s61, 49152
    s_add_u32 s66, s66, 16777216
    s_lshl_b32 s3, s95, 10
    s_add_u32 s66, s66, s3
    s_add_u32 s67, s66, 49152
    s_mul_i32 s68, s61, 20480
    s_add_u32 s68, s68, 12582912
    s_add_u32 s69, s68, 20480
    s_lshl_b32 s3, s58, 10
    s_add_u32 s3, s3, 16777216
    s_mul_i32 s70, s59, 49152
    s_add_u32 s70, s70, s3
    s_xor_b32 s61, s59, 1
    s_mul_i32 s71, s61, 49152
    s_add_u32 s71, s71, s3
    s_lshl_b32 s72, s59, 9
    s_add_u32 s72, s72, 131072
    s_mul_i32 s73, s58, 5120
    s_mov_b32 s86, 0
    s_mov_b32 s87, 4096
    s_mov_b32 s88, 8192
    s_mov_b32 s89, 12288
    s_waitcnt vmcnt(1)
    s_waitcnt lgkmcnt(0)
    s_barrier
    s_barrier
    buffer_load_dwordx4 v[88:91], v7, s[36:39], s68 offen offset:0 sc1
    buffer_load_dwordx4 v[92:95], v7, s[36:39], s69 offen offset:0 sc1
    buffer_load_dwordx4 v[96:99], v7, s[36:39], s68 offen offset:1024 sc1
    buffer_load_dwordx4 v[100:103], v7, s[36:39], s69 offen offset:1024 sc1
    ds_read_b64_tr_b16 v[8:9], v4 offset:0
    ds_read_b64_tr_b16 v[10:11], v4 offset:512
    ds_read_b64_tr_b16 v[12:13], v4 offset:1024
    ds_read_b64_tr_b16 v[14:15], v4 offset:1536
    ds_read_b64_tr_b16 v[16:17], v4 offset:2048
    ds_read_b64_tr_b16 v[18:19], v4 offset:2560
    s_waitcnt vmcnt(2)
    s_waitcnt lgkmcnt(4)
    v_mfma_f32_16x16x32_bf16 v[24:27], v[8:11], v[88:91], 0
    ds_read_b64_tr_b16 v[20:21], v4 offset:3072
    v_mfma_f32_16x16x32_bf16 v[28:31], v[8:11], v[92:95], 0
    ds_read_b64_tr_b16 v[22:23], v4 offset:3584
    s_waitcnt lgkmcnt(4)
    v_mfma_f32_16x16x32_bf16 v[32:35], v[12:15], v[88:91], 0
    ds_read_b64_tr_b16 v[8:9], v4 offset:4096
    v_mfma_f32_16x16x32_bf16 v[36:39], v[12:15], v[92:95], 0
    ds_read_b64_tr_b16 v[10:11], v4 offset:4608
    s_waitcnt lgkmcnt(4)
    v_mfma_f32_16x16x32_bf16 v[40:43], v[16:19], v[88:91], 0
    ds_read_b64_tr_b16 v[12:13], v4 offset:5120
    v_mfma_f32_16x16x32_bf16 v[44:47], v[16:19], v[92:95], 0
    ds_read_b64_tr_b16 v[14:15], v4 offset:5632
    s_waitcnt lgkmcnt(4)
    v_mfma_f32_16x16x32_bf16 v[48:51], v[20:23], v[88:91], 0
    ds_read_b64_tr_b16 v[16:17], v4 offset:6144
    v_mfma_f32_16x16x32_bf16 v[52:55], v[20:23], v[92:95], 0
    ds_read_b64_tr_b16 v[18:19], v4 offset:6656
    s_waitcnt lgkmcnt(4)
    v_mfma_f32_16x16x32_bf16 v[56:59], v[8:11], v[88:91], 0
    ds_read_b64_tr_b16 v[20:21], v4 offset:7168
    v_mfma_f32_16x16x32_bf16 v[60:63], v[8:11], v[92:95], 0
    ds_read_b64_tr_b16 v[22:23], v4 offset:7680
    s_waitcnt lgkmcnt(4)
    v_mfma_f32_16x16x32_bf16 v[64:67], v[12:15], v[88:91], 0
    ds_read_b64_tr_b16 v[8:9], v4 offset:8192
    v_mfma_f32_16x16x32_bf16 v[68:71], v[12:15], v[92:95], 0
    ds_read_b64_tr_b16 v[10:11], v4 offset:8704
    s_waitcnt lgkmcnt(4)
    v_mfma_f32_16x16x32_bf16 v[72:75], v[16:19], v[88:91], 0
    ds_read_b64_tr_b16 v[12:13], v4 offset:9216
    v_mfma_f32_16x16x32_bf16 v[76:79], v[16:19], v[92:95], 0
    ds_read_b64_tr_b16 v[14:15], v4 offset:9728
    s_waitcnt lgkmcnt(4)
    v_mfma_f32_16x16x32_bf16 v[80:83], v[20:23], v[88:91], 0
    s_barrier
    ds_read_b64_tr_b16 v[16:17], v4 offset:10240
    ds_read_b128 v[104:107], v252 offset:20480
    v_mfma_f32_16x16x32_bf16 v[84:87], v[20:23], v[92:95], 0
    ds_read_b64_tr_b16 v[18:19], v4 offset:10752
    ds_read_b128 v[108:111], v252 offset:21504
    s_waitcnt vmcnt(0)
    s_waitcnt lgkmcnt(6)
    v_mfma_f32_16x16x32_bf16 v[24:27], v[8:11], v[96:99], v[24:27]
    ds_read_b64_tr_b16 v[20:21], v4 offset:11264
    ds_read_b128 v[112:115], v252 offset:22528
    v_mfma_f32_16x16x32_bf16 v[28:31], v[8:11], v[100:103], v[28:31]
    ds_read_b64_tr_b16 v[22:23], v4 offset:11776
    ds_read_b128 v[116:119], v252 offset:23552
    s_waitcnt lgkmcnt(8)
    v_mfma_f32_16x16x32_bf16 v[32:35], v[12:15], v[96:99], v[32:35]
    ds_read_b64_tr_b16 v[8:9], v4 offset:12288
    v_mfma_f32_16x16x32_bf16 v[36:39], v[12:15], v[100:103], v[36:39]
    ds_read_b64_tr_b16 v[10:11], v4 offset:12800
    s_waitcnt lgkmcnt(7)
    v_mfma_f32_16x16x32_bf16 v[40:43], v[16:19], v[96:99], v[40:43]
    ds_read_b64_tr_b16 v[12:13], v4 offset:13312
    v_mfma_f32_16x16x32_bf16 v[44:47], v[16:19], v[100:103], v[44:47]
    ds_read_b64_tr_b16 v[14:15], v4 offset:13824
    s_waitcnt lgkmcnt(5)
    v_mfma_f32_16x16x32_bf16 v[48:51], v[20:23], v[96:99], v[48:51]
    ds_read_b64_tr_b16 v[16:17], v4 offset:14336
    v_mfma_f32_16x16x32_bf16 v[52:55], v[20:23], v[100:103], v[52:55]
    ds_read_b64_tr_b16 v[18:19], v4 offset:14848
    s_waitcnt lgkmcnt(4)
    v_mfma_f32_16x16x32_bf16 v[56:59], v[8:11], v[96:99], v[56:59]
    ds_read_b64_tr_b16 v[20:21], v4 offset:15360
    v_mfma_f32_16x16x32_bf16 v[60:63], v[8:11], v[100:103], v[60:63]
    ds_read_b64_tr_b16 v[22:23], v4 offset:15872
    s_waitcnt lgkmcnt(4)
    v_mfma_f32_16x16x32_bf16 v[64:67], v[12:15], v[96:99], v[64:67]
    ds_read_b64_tr_b16 v[8:9], v4 offset:16384
    v_mfma_f32_16x16x32_bf16 v[68:71], v[12:15], v[100:103], v[68:71]
    ds_read_b64_tr_b16 v[10:11], v4 offset:16896
    s_waitcnt lgkmcnt(4)
    v_mfma_f32_16x16x32_bf16 v[72:75], v[16:19], v[96:99], v[72:75]
    ds_read_b64_tr_b16 v[12:13], v4 offset:17408
    v_mfma_f32_16x16x32_bf16 v[76:79], v[16:19], v[100:103], v[76:79]
    ds_read_b64_tr_b16 v[14:15], v4 offset:17920
    s_waitcnt lgkmcnt(4)
    v_mfma_f32_16x16x32_bf16 v[80:83], v[20:23], v[96:99], v[80:83]
    ds_read_b64_tr_b16 v[16:17], v4 offset:18432
    v_mfma_f32_16x16x32_bf16 v[84:87], v[20:23], v[100:103], v[84:87]
    ds_read_b64_tr_b16 v[18:19], v4 offset:18944
    s_waitcnt lgkmcnt(4)
    v_mfma_f32_16x16x32_bf16 v[24:27], v[8:11], v[104:107], v[24:27]
    ds_read_b64_tr_b16 v[20:21], v4 offset:19456
    v_mfma_f32_16x16x32_bf16 v[28:31], v[8:11], v[108:111], v[28:31]
    ds_read_b64_tr_b16 v[22:23], v4 offset:19968
    s_waitcnt lgkmcnt(4)
    v_mfma_f32_16x16x32_bf16 v[32:35], v[12:15], v[104:107], v[32:35]
    s_barrier
    ds_read_b64_tr_b16 v[8:9], v5 offset:4096
    v_mfma_f32_16x16x32_bf16 v[36:39], v[12:15], v[108:111], v[36:39]
    ds_read_b64_tr_b16 v[10:11], v5 offset:4608
    s_waitcnt lgkmcnt(4)
    v_mfma_f32_16x16x32_bf16 v[40:43], v[16:19], v[104:107], v[40:43]
    ds_read_b64_tr_b16 v[12:13], v5 offset:5120
    v_mfma_f32_16x16x32_bf16 v[44:47], v[16:19], v[108:111], v[44:47]
    ds_read_b64_tr_b16 v[14:15], v5 offset:5632
    s_waitcnt lgkmcnt(4)
    v_mfma_f32_16x16x32_bf16 v[48:51], v[20:23], v[104:107], v[48:51]
    ds_read_b64_tr_b16 v[16:17], v5 offset:6144
    v_mfma_f32_16x16x32_bf16 v[52:55], v[20:23], v[108:111], v[52:55]
    ds_read_b64_tr_b16 v[18:19], v5 offset:6656
    s_waitcnt lgkmcnt(4)
    v_mfma_f32_16x16x32_bf16 v[56:59], v[8:11], v[104:107], v[56:59]
    ds_read_b64_tr_b16 v[20:21], v5 offset:7168
    v_mfma_f32_16x16x32_bf16 v[60:63], v[8:11], v[108:111], v[60:63]
    ds_read_b64_tr_b16 v[22:23], v5 offset:7680
    s_waitcnt lgkmcnt(4)
    v_mfma_f32_16x16x32_bf16 v[64:67], v[12:15], v[104:107], v[64:67]
    ds_read_b64_tr_b16 v[8:9], v5 offset:8192
    v_mfma_f32_16x16x32_bf16 v[68:71], v[12:15], v[108:111], v[68:71]
    ds_read_b64_tr_b16 v[10:11], v5 offset:8704
    s_waitcnt lgkmcnt(4)
    v_mfma_f32_16x16x32_bf16 v[72:75], v[16:19], v[104:107], v[72:75]
    ds_read_b64_tr_b16 v[12:13], v5 offset:9216
    v_mfma_f32_16x16x32_bf16 v[76:79], v[16:19], v[108:111], v[76:79]
    ds_read_b64_tr_b16 v[14:15], v5 offset:9728
    s_waitcnt lgkmcnt(4)
    v_mfma_f32_16x16x32_bf16 v[80:83], v[20:23], v[104:107], v[80:83]
    ds_read_b64_tr_b16 v[16:17], v5 offset:10240
    v_mfma_f32_16x16x32_bf16 v[84:87], v[20:23], v[108:111], v[84:87]
    ds_read_b64_tr_b16 v[18:19], v5 offset:10752
    s_waitcnt lgkmcnt(4)
    v_mfma_f32_16x16x32_bf16 v[24:27], v[8:11], v[112:115], v[24:27]
    ds_read_b64_tr_b16 v[20:21], v5 offset:11264
    v_mfma_f32_16x16x32_bf16 v[28:31], v[8:11], v[116:119], v[28:31]
    ds_read_b64_tr_b16 v[22:23], v5 offset:11776
    s_waitcnt lgkmcnt(4)
    v_mfma_f32_16x16x32_bf16 v[32:35], v[12:15], v[112:115], v[32:35]
    ds_read_b64_tr_b16 v[8:9], v5 offset:12288
    v_mfma_f32_16x16x32_bf16 v[36:39], v[12:15], v[116:119], v[36:39]
    ds_read_b64_tr_b16 v[10:11], v5 offset:12800
    s_waitcnt lgkmcnt(4)
    v_mfma_f32_16x16x32_bf16 v[40:43], v[16:19], v[112:115], v[40:43]
    ds_read_b64_tr_b16 v[12:13], v5 offset:13312
    v_mfma_f32_16x16x32_bf16 v[44:47], v[16:19], v[116:119], v[44:47]
    ds_read_b64_tr_b16 v[14:15], v5 offset:13824
    s_waitcnt lgkmcnt(4)
    v_mfma_f32_16x16x32_bf16 v[48:51], v[20:23], v[112:115], v[48:51]
    s_barrier
    ds_read_b64_tr_b16 v[16:17], v5 offset:14336
    ds_read_b128 v[120:123], v252 offset:40960
    v_mfma_f32_16x16x32_bf16 v[52:55], v[20:23], v[116:119], v[52:55]
    ds_read_b64_tr_b16 v[18:19], v5 offset:14848
    ds_read_b128 v[124:127], v252 offset:41984
    s_waitcnt lgkmcnt(6)
    v_mfma_f32_16x16x32_bf16 v[56:59], v[8:11], v[112:115], v[56:59]
    ds_read_b64_tr_b16 v[20:21], v5 offset:15360
    ds_read_b128 v[128:131], v252 offset:43008
    v_mfma_f32_16x16x32_bf16 v[60:63], v[8:11], v[116:119], v[60:63]
    ds_read_b64_tr_b16 v[22:23], v5 offset:15872
    ds_read_b128 v[132:135], v252 offset:44032
    s_waitcnt lgkmcnt(8)
    v_mfma_f32_16x16x32_bf16 v[64:67], v[12:15], v[112:115], v[64:67]
    ds_read_b64_tr_b16 v[8:9], v5 offset:16384
    v_mfma_f32_16x16x32_bf16 v[68:71], v[12:15], v[116:119], v[68:71]
    ds_read_b64_tr_b16 v[10:11], v5 offset:16896
    s_waitcnt lgkmcnt(7)
    v_mfma_f32_16x16x32_bf16 v[72:75], v[16:19], v[112:115], v[72:75]
    ds_read_b64_tr_b16 v[12:13], v5 offset:17408
    v_mfma_f32_16x16x32_bf16 v[76:79], v[16:19], v[116:119], v[76:79]
    ds_read_b64_tr_b16 v[14:15], v5 offset:17920
    s_waitcnt lgkmcnt(5)
    v_mfma_f32_16x16x32_bf16 v[80:83], v[20:23], v[112:115], v[80:83]
    ds_read_b64_tr_b16 v[16:17], v5 offset:18432
    v_mfma_f32_16x16x32_bf16 v[84:87], v[20:23], v[116:119], v[84:87]
    ds_read_b64_tr_b16 v[18:19], v5 offset:18944
    s_waitcnt lgkmcnt(6)
    s_waitcnt lgkmcnt(4)
    v_mfma_f32_16x16x32_bf16 v[24:27], v[8:11], v[120:123], v[24:27]
    ds_read_b64_tr_b16 v[20:21], v5 offset:19456
    v_mfma_f32_16x16x32_bf16 v[28:31], v[8:11], v[124:127], v[28:31]
    ds_read_b64_tr_b16 v[22:23], v5 offset:19968
    s_waitcnt lgkmcnt(4)
    v_mfma_f32_16x16x32_bf16 v[32:35], v[12:15], v[120:123], v[32:35]
    ds_read_b64_tr_b16 v[8:9], v5 offset:20480
    v_mfma_f32_16x16x32_bf16 v[36:39], v[12:15], v[124:127], v[36:39]
    ds_read_b64_tr_b16 v[10:11], v5 offset:20992
    s_waitcnt lgkmcnt(4)
    v_mfma_f32_16x16x32_bf16 v[40:43], v[16:19], v[120:123], v[40:43]
    ds_read_b64_tr_b16 v[12:13], v5 offset:21504
    v_mfma_f32_16x16x32_bf16 v[44:47], v[16:19], v[124:127], v[44:47]
    ds_read_b64_tr_b16 v[14:15], v5 offset:22016
    s_waitcnt lgkmcnt(4)
    v_mfma_f32_16x16x32_bf16 v[48:51], v[20:23], v[120:123], v[48:51]
    ds_read_b64_tr_b16 v[16:17], v5 offset:22528
    v_mfma_f32_16x16x32_bf16 v[52:55], v[20:23], v[124:127], v[52:55]
    ds_read_b64_tr_b16 v[18:19], v5 offset:23040
    s_waitcnt lgkmcnt(4)
    v_mfma_f32_16x16x32_bf16 v[56:59], v[8:11], v[120:123], v[56:59]
    ds_read_b64_tr_b16 v[20:21], v5 offset:23552
    v_mfma_f32_16x16x32_bf16 v[60:63], v[8:11], v[124:127], v[60:63]
    ds_read_b64_tr_b16 v[22:23], v5 offset:24064
    s_waitcnt lgkmcnt(4)
    v_mfma_f32_16x16x32_bf16 v[64:67], v[12:15], v[120:123], v[64:67]
    s_barrier
    ds_read_b64_tr_b16 v[8:9], v5 offset:24576
    ds_read_b128 v[136:139], v254 offset:8192
    v_mfma_f32_16x16x32_bf16 v[68:71], v[12:15], v[124:127], v[68:71]
    ds_read_b64_tr_b16 v[10:11], v5 offset:25088
    ds_read_b128 v[140:143], v254 offset:9216
    s_waitcnt lgkmcnt(6)
    v_mfma_f32_16x16x32_bf16 v[72:75], v[16:19], v[120:123], v[72:75]
    ds_read_b64_tr_b16 v[12:13], v5 offset:25600
    ds_read_b128 v[144:147], v254 offset:10240
    v_mfma_f32_16x16x32_bf16 v[76:79], v[16:19], v[124:127], v[76:79]
    ds_read_b64_tr_b16 v[14:15], v5 offset:26112
    ds_read_b128 v[148:151], v254 offset:11264
    s_waitcnt lgkmcnt(8)
    v_mfma_f32_16x16x32_bf16 v[80:83], v[20:23], v[120:123], v[80:83]
    ds_read_b64_tr_b16 v[16:17], v5 offset:26624
    v_mfma_f32_16x16x32_bf16 v[84:87], v[20:23], v[124:127], v[84:87]
    ds_read_b64_tr_b16 v[18:19], v5 offset:27136
    s_waitcnt lgkmcnt(7)
    v_mfma_f32_16x16x32_bf16 v[24:27], v[8:11], v[128:131], v[24:27]
    ds_read_b64_tr_b16 v[20:21], v5 offset:27648
    v_mfma_f32_16x16x32_bf16 v[28:31], v[8:11], v[132:135], v[28:31]
    ds_read_b64_tr_b16 v[22:23], v5 offset:28160
    s_waitcnt lgkmcnt(5)
    v_mfma_f32_16x16x32_bf16 v[32:35], v[12:15], v[128:131], v[32:35]
    ds_read_b64_tr_b16 v[8:9], v5 offset:28672
    v_mfma_f32_16x16x32_bf16 v[36:39], v[12:15], v[132:135], v[36:39]
    ds_read_b64_tr_b16 v[10:11], v5 offset:29184
    s_waitcnt lgkmcnt(4)
    v_mfma_f32_16x16x32_bf16 v[40:43], v[16:19], v[128:131], v[40:43]
    ds_read_b64_tr_b16 v[12:13], v5 offset:29696
    v_mfma_f32_16x16x32_bf16 v[44:47], v[16:19], v[132:135], v[44:47]
    ds_read_b64_tr_b16 v[14:15], v5 offset:30208
    s_waitcnt lgkmcnt(4)
    v_mfma_f32_16x16x32_bf16 v[48:51], v[20:23], v[128:131], v[48:51]
    ds_read_b64_tr_b16 v[16:17], v5 offset:30720
    v_mfma_f32_16x16x32_bf16 v[52:55], v[20:23], v[132:135], v[52:55]
    ds_read_b64_tr_b16 v[18:19], v5 offset:31232
    s_waitcnt lgkmcnt(4)
    v_mfma_f32_16x16x32_bf16 v[56:59], v[8:11], v[128:131], v[56:59]
    ds_read_b64_tr_b16 v[20:21], v5 offset:31744
    v_mfma_f32_16x16x32_bf16 v[60:63], v[8:11], v[132:135], v[60:63]
    ds_read_b64_tr_b16 v[22:23], v5 offset:32256
    s_waitcnt lgkmcnt(4)
    v_mfma_f32_16x16x32_bf16 v[64:67], v[12:15], v[128:131], v[64:67]
    ds_read_b64_tr_b16 v[8:9], v5 offset:32768
    v_mfma_f32_16x16x32_bf16 v[68:71], v[12:15], v[132:135], v[68:71]
    ds_read_b64_tr_b16 v[10:11], v5 offset:33280
    s_waitcnt lgkmcnt(4)
    v_mfma_f32_16x16x32_bf16 v[72:75], v[16:19], v[128:131], v[72:75]
    ds_read_b64_tr_b16 v[12:13], v5 offset:33792
    v_mfma_f32_16x16x32_bf16 v[76:79], v[16:19], v[132:135], v[76:79]
    ds_read_b64_tr_b16 v[14:15], v5 offset:34304
    s_waitcnt lgkmcnt(4)
    v_mfma_f32_16x16x32_bf16 v[80:83], v[20:23], v[128:131], v[80:83]
    s_barrier
    ds_read_b64_tr_b16 v[16:17], v5 offset:34816
    ds_read_b128 v[152:155], v254 offset:28672
    v_mfma_f32_16x16x32_bf16 v[84:87], v[20:23], v[132:135], v[84:87]
    ds_read_b64_tr_b16 v[18:19], v5 offset:35328
    ds_read_b128 v[156:159], v254 offset:29696
    s_waitcnt lgkmcnt(6)
    v_mfma_f32_16x16x32_bf16 v[24:27], v[8:11], v[136:139], v[24:27]
    ds_read_b64_tr_b16 v[20:21], v5 offset:35840
    ds_read_b128 v[160:163], v254 offset:30720
    v_mfma_f32_16x16x32_bf16 v[28:31], v[8:11], v[140:143], v[28:31]
    ds_read_b64_tr_b16 v[22:23], v5 offset:36352
    ds_read_b128 v[164:167], v254 offset:31744
    s_waitcnt lgkmcnt(8)
    v_mfma_f32_16x16x32_bf16 v[32:35], v[12:15], v[136:139], v[32:35]
    ds_read_b64_tr_b16 v[8:9], v5 offset:36864
    v_mfma_f32_16x16x32_bf16 v[36:39], v[12:15], v[140:143], v[36:39]
    ds_read_b64_tr_b16 v[10:11], v5 offset:37376
    s_waitcnt lgkmcnt(7)
    v_mfma_f32_16x16x32_bf16 v[40:43], v[16:19], v[136:139], v[40:43]
    ds_read_b64_tr_b16 v[12:13], v5 offset:37888
    v_mfma_f32_16x16x32_bf16 v[44:47], v[16:19], v[140:143], v[44:47]
    ds_read_b64_tr_b16 v[14:15], v5 offset:38400
    s_waitcnt lgkmcnt(5)
    v_mfma_f32_16x16x32_bf16 v[48:51], v[20:23], v[136:139], v[48:51]
    ds_read_b64_tr_b16 v[16:17], v5 offset:38912
    v_mfma_f32_16x16x32_bf16 v[52:55], v[20:23], v[140:143], v[52:55]
    ds_read_b64_tr_b16 v[18:19], v5 offset:39424
    s_waitcnt lgkmcnt(4)
    v_mfma_f32_16x16x32_bf16 v[56:59], v[8:11], v[136:139], v[56:59]
    ds_read_b64_tr_b16 v[20:21], v5 offset:39936
    v_mfma_f32_16x16x32_bf16 v[60:63], v[8:11], v[140:143], v[60:63]
    ds_read_b64_tr_b16 v[22:23], v5 offset:40448
    s_waitcnt lgkmcnt(4)
    v_mfma_f32_16x16x32_bf16 v[64:67], v[12:15], v[136:139], v[64:67]
    ds_read_b64_tr_b16 v[8:9], v5 offset:40960
    v_mfma_f32_16x16x32_bf16 v[68:71], v[12:15], v[140:143], v[68:71]
    ds_read_b64_tr_b16 v[10:11], v5 offset:41472
    s_waitcnt lgkmcnt(4)
    v_mfma_f32_16x16x32_bf16 v[72:75], v[16:19], v[136:139], v[72:75]
    ds_read_b64_tr_b16 v[12:13], v5 offset:41984
    v_mfma_f32_16x16x32_bf16 v[76:79], v[16:19], v[140:143], v[76:79]
    ds_read_b64_tr_b16 v[14:15], v5 offset:42496
    s_waitcnt lgkmcnt(4)
    v_mfma_f32_16x16x32_bf16 v[80:83], v[20:23], v[136:139], v[80:83]
    ds_read_b64_tr_b16 v[16:17], v5 offset:43008
    v_mfma_f32_16x16x32_bf16 v[84:87], v[20:23], v[140:143], v[84:87]
    ds_read_b64_tr_b16 v[18:19], v5 offset:43520
    s_waitcnt lgkmcnt(4)
    v_mfma_f32_16x16x32_bf16 v[24:27], v[8:11], v[144:147], v[24:27]
    ds_read_b64_tr_b16 v[20:21], v5 offset:44032
    v_mfma_f32_16x16x32_bf16 v[28:31], v[8:11], v[148:151], v[28:31]
    ds_read_b64_tr_b16 v[22:23], v5 offset:44544
    s_waitcnt lgkmcnt(4)
    v_mfma_f32_16x16x32_bf16 v[32:35], v[12:15], v[144:147], v[32:35]
    s_barrier
    ds_read_b64_tr_b16 v[8:9], v5 offset:45056
    ds_read_b128 v[168:171], v252 offset:20480
    v_mfma_f32_16x16x32_bf16 v[36:39], v[12:15], v[148:151], v[36:39]
    ds_read_b64_tr_b16 v[10:11], v5 offset:45568
    ds_read_b128 v[172:175], v252 offset:21504
    s_waitcnt lgkmcnt(6)
    v_mfma_f32_16x16x32_bf16 v[40:43], v[16:19], v[144:147], v[40:43]
    ds_read_b64_tr_b16 v[12:13], v5 offset:46080
    ds_read_b128 v[176:179], v252 offset:22528
    v_mfma_f32_16x16x32_bf16 v[44:47], v[16:19], v[148:151], v[44:47]
    ds_read_b64_tr_b16 v[14:15], v5 offset:46592
    ds_read_b128 v[180:183], v252 offset:23552
    s_waitcnt lgkmcnt(8)
    v_mfma_f32_16x16x32_bf16 v[48:51], v[20:23], v[144:147], v[48:51]
    ds_read_b64_tr_b16 v[16:17], v5 offset:47104
    v_mfma_f32_16x16x32_bf16 v[52:55], v[20:23], v[148:151], v[52:55]
    ds_read_b64_tr_b16 v[18:19], v5 offset:47616
    s_waitcnt lgkmcnt(7)
    v_mfma_f32_16x16x32_bf16 v[56:59], v[8:11], v[144:147], v[56:59]
    ds_read_b64_tr_b16 v[20:21], v5 offset:48128
    v_mfma_f32_16x16x32_bf16 v[60:63], v[8:11], v[148:151], v[60:63]
    ds_read_b64_tr_b16 v[22:23], v5 offset:48640
    s_waitcnt lgkmcnt(5)
    v_mfma_f32_16x16x32_bf16 v[64:67], v[12:15], v[144:147], v[64:67]
    ds_read_b64_tr_b16 v[8:9], v5 offset:49152
    v_mfma_f32_16x16x32_bf16 v[68:71], v[12:15], v[148:151], v[68:71]
    ds_read_b64_tr_b16 v[10:11], v5 offset:49664
    s_waitcnt lgkmcnt(4)
    v_mfma_f32_16x16x32_bf16 v[72:75], v[16:19], v[144:147], v[72:75]
    ds_read_b64_tr_b16 v[12:13], v5 offset:50176
    v_mfma_f32_16x16x32_bf16 v[76:79], v[16:19], v[148:151], v[76:79]
    ds_read_b64_tr_b16 v[14:15], v5 offset:50688
    s_waitcnt lgkmcnt(4)
    v_mfma_f32_16x16x32_bf16 v[80:83], v[20:23], v[144:147], v[80:83]
    ds_read_b64_tr_b16 v[16:17], v5 offset:51200
    v_mfma_f32_16x16x32_bf16 v[84:87], v[20:23], v[148:151], v[84:87]
    ds_read_b64_tr_b16 v[18:19], v5 offset:51712
    s_waitcnt lgkmcnt(4)
    v_mfma_f32_16x16x32_bf16 v[24:27], v[8:11], v[152:155], v[24:27]
    ds_read_b64_tr_b16 v[20:21], v5 offset:52224
    v_mfma_f32_16x16x32_bf16 v[28:31], v[8:11], v[156:159], v[28:31]
    ds_read_b64_tr_b16 v[22:23], v5 offset:52736
    s_waitcnt lgkmcnt(4)
    v_mfma_f32_16x16x32_bf16 v[32:35], v[12:15], v[152:155], v[32:35]
    ds_read_b64_tr_b16 v[8:9], v5 offset:53248
    v_mfma_f32_16x16x32_bf16 v[36:39], v[12:15], v[156:159], v[36:39]
    ds_read_b64_tr_b16 v[10:11], v5 offset:53760
    s_waitcnt lgkmcnt(4)
    v_mfma_f32_16x16x32_bf16 v[40:43], v[16:19], v[152:155], v[40:43]
    ds_read_b64_tr_b16 v[12:13], v5 offset:54272
    v_mfma_f32_16x16x32_bf16 v[44:47], v[16:19], v[156:159], v[44:47]
    ds_read_b64_tr_b16 v[14:15], v5 offset:54784
    s_waitcnt lgkmcnt(4)
    v_mfma_f32_16x16x32_bf16 v[48:51], v[20:23], v[152:155], v[48:51]
    s_barrier
    ds_read_b64_tr_b16 v[16:17], v5 offset:55296
    ds_read_b128 v[184:187], v252 offset:0
    v_mfma_f32_16x16x32_bf16 v[52:55], v[20:23], v[156:159], v[52:55]
    ds_read_b64_tr_b16 v[18:19], v5 offset:55808
    ds_read_b128 v[188:191], v252 offset:1024
    s_waitcnt lgkmcnt(6)
    v_mfma_f32_16x16x32_bf16 v[24:27], v[8:11], v[160:163], v[24:27]
    ds_read_b64_tr_b16 v[20:21], v5 offset:56320
    ds_read_b128 v[192:195], v252 offset:2048
    v_mfma_f32_16x16x32_bf16 v[28:31], v[8:11], v[164:167], v[28:31]
    ds_read_b64_tr_b16 v[22:23], v5 offset:56832
    ds_read_b128 v[196:199], v252 offset:3072
    s_waitcnt lgkmcnt(8)
    v_mfma_f32_16x16x32_bf16 v[32:35], v[12:15], v[160:163], v[32:35]
    ds_read_b64_tr_b16 v[8:9], v6 offset:0
    v_mfma_f32_16x16x32_bf16 v[36:39], v[12:15], v[164:167], v[36:39]
    ds_read_b64_tr_b16 v[10:11], v6 offset:512
    s_waitcnt lgkmcnt(7)
    v_mfma_f32_16x16x32_bf16 v[40:43], v[16:19], v[160:163], v[40:43]
    ds_read_b64_tr_b16 v[12:13], v6 offset:1024
    v_mfma_f32_16x16x32_bf16 v[44:47], v[16:19], v[164:167], v[44:47]
    ds_read_b64_tr_b16 v[14:15], v6 offset:1536
    s_waitcnt lgkmcnt(5)
    v_mfma_f32_16x16x32_bf16 v[48:51], v[20:23], v[160:163], v[48:51]
    ds_read_b64_tr_b16 v[16:17], v6 offset:2048
    v_mfma_f32_16x16x32_bf16 v[52:55], v[20:23], v[164:167], v[52:55]
    ds_read_b64_tr_b16 v[18:19], v6 offset:2560
    s_waitcnt lgkmcnt(4)
    v_mfma_f32_16x16x32_bf16 v[24:27], v[8:11], v[168:171], v[24:27]
    ds_read_b64_tr_b16 v[20:21], v6 offset:3072
    v_mfma_f32_16x16x32_bf16 v[28:31], v[8:11], v[172:175], v[28:31]
    ds_read_b64_tr_b16 v[22:23], v6 offset:3584
    s_waitcnt lgkmcnt(4)
    v_mfma_f32_16x16x32_bf16 v[32:35], v[12:15], v[168:171], v[32:35]
    ds_read_b64_tr_b16 v[8:9], v6 offset:4096
    v_mfma_f32_16x16x32_bf16 v[36:39], v[12:15], v[172:175], v[36:39]
    ds_read_b64_tr_b16 v[10:11], v6 offset:4608
    s_waitcnt lgkmcnt(4)
    v_mfma_f32_16x16x32_bf16 v[40:43], v[16:19], v[168:171], v[40:43]
    ds_read_b64_tr_b16 v[12:13], v6 offset:5120
    v_mfma_f32_16x16x32_bf16 v[44:47], v[16:19], v[172:175], v[44:47]
    ds_read_b64_tr_b16 v[14:15], v6 offset:5632
    s_waitcnt lgkmcnt(4)
    v_mfma_f32_16x16x32_bf16 v[48:51], v[20:23], v[168:171], v[48:51]
    ds_read_b64_tr_b16 v[16:17], v6 offset:6144
    v_mfma_f32_16x16x32_bf16 v[52:55], v[20:23], v[172:175], v[52:55]
    ds_read_b64_tr_b16 v[18:19], v6 offset:6656
    s_waitcnt lgkmcnt(4)
    v_mfma_f32_16x16x32_bf16 v[24:27], v[8:11], v[176:179], v[24:27]
    ds_read_b64_tr_b16 v[20:21], v6 offset:7168
    v_mfma_f32_16x16x32_bf16 v[28:31], v[8:11], v[180:183], v[28:31]
    ds_read_b64_tr_b16 v[22:23], v6 offset:7680
    s_waitcnt lgkmcnt(4)
    v_mfma_f32_16x16x32_bf16 v[32:35], v[12:15], v[176:179], v[32:35]
    s_barrier
    ds_read_b64_tr_b16 v[8:9], v5 offset:4096
    ds_read_b128 v[200:203], v252 offset:40960
    v_mfma_f32_16x16x32_bf16 v[36:39], v[12:15], v[180:183], v[36:39]
    ds_read_b64_tr_b16 v[10:11], v5 offset:4608
    ds_read_b128 v[204:207], v252 offset:41984
    s_waitcnt lgkmcnt(6)
    v_mfma_f32_16x16x32_bf16 v[40:43], v[16:19], v[176:179], v[40:43]
    ds_read_b64_tr_b16 v[12:13], v5 offset:5120
    ds_read_b128 v[208:211], v252 offset:43008
    v_mfma_f32_16x16x32_bf16 v[44:47], v[16:19], v[180:183], v[44:47]
    ds_read_b64_tr_b16 v[14:15], v5 offset:5632
    ds_read_b128 v[212:215], v252 offset:44032
    s_waitcnt lgkmcnt(8)
    v_mfma_f32_16x16x32_bf16 v[48:51], v[20:23], v[176:179], v[48:51]
    ds_read_b64_tr_b16 v[16:17], v5 offset:6144
    v_mfma_f32_16x16x32_bf16 v[52:55], v[20:23], v[180:183], v[52:55]
    ds_read_b64_tr_b16 v[18:19], v5 offset:6656
    s_waitcnt lgkmcnt(7)
    v_mfma_f32_16x16x32_bf16 v[24:27], v[8:11], v[184:187], v[24:27]
    ds_read_b64_tr_b16 v[20:21], v5 offset:7168
    v_mfma_f32_16x16x32_bf16 v[28:31], v[8:11], v[188:191], v[28:31]
    ds_read_b64_tr_b16 v[22:23], v5 offset:7680
    s_waitcnt lgkmcnt(5)
    v_mfma_f32_16x16x32_bf16 v[32:35], v[12:15], v[184:187], v[32:35]
    ds_read_b64_tr_b16 v[8:9], v5 offset:8192
    v_mfma_f32_16x16x32_bf16 v[36:39], v[12:15], v[188:191], v[36:39]
    ds_read_b64_tr_b16 v[10:11], v5 offset:8704
    s_waitcnt lgkmcnt(4)
    v_mfma_f32_16x16x32_bf16 v[40:43], v[16:19], v[184:187], v[40:43]
    ds_read_b64_tr_b16 v[12:13], v5 offset:9216
    v_mfma_f32_16x16x32_bf16 v[44:47], v[16:19], v[188:191], v[44:47]
    ds_read_b64_tr_b16 v[14:15], v5 offset:9728
    s_waitcnt lgkmcnt(4)
    v_mfma_f32_16x16x32_bf16 v[48:51], v[20:23], v[184:187], v[48:51]
    ds_read_b64_tr_b16 v[16:17], v5 offset:10240
    v_mfma_f32_16x16x32_bf16 v[52:55], v[20:23], v[188:191], v[52:55]
    ds_read_b64_tr_b16 v[18:19], v5 offset:10752
    s_waitcnt lgkmcnt(4)
    v_mfma_f32_16x16x32_bf16 v[24:27], v[8:11], v[192:195], v[24:27]
    ds_read_b64_tr_b16 v[20:21], v5 offset:11264
    v_mfma_f32_16x16x32_bf16 v[28:31], v[8:11], v[196:199], v[28:31]
    ds_read_b64_tr_b16 v[22:23], v5 offset:11776
    s_waitcnt lgkmcnt(4)
    v_mfma_f32_16x16x32_bf16 v[32:35], v[12:15], v[192:195], v[32:35]
    ds_read_b64_tr_b16 v[8:9], v5 offset:12288
    v_mfma_f32_16x16x32_bf16 v[36:39], v[12:15], v[196:199], v[36:39]
    ds_read_b64_tr_b16 v[10:11], v5 offset:12800
    s_waitcnt lgkmcnt(4)
    v_mfma_f32_16x16x32_bf16 v[40:43], v[16:19], v[192:195], v[40:43]
    ds_read_b64_tr_b16 v[12:13], v5 offset:13312
    v_mfma_f32_16x16x32_bf16 v[44:47], v[16:19], v[196:199], v[44:47]
    ds_read_b64_tr_b16 v[14:15], v5 offset:13824
    s_waitcnt lgkmcnt(4)
    v_mfma_f32_16x16x32_bf16 v[48:51], v[20:23], v[192:195], v[48:51]
    s_barrier
    ds_read_b64_tr_b16 v[16:17], v5 offset:14336
    ds_read_b128 v[216:219], v254 offset:8192
    v_mfma_f32_16x16x32_bf16 v[52:55], v[20:23], v[196:199], v[52:55]
    ds_read_b64_tr_b16 v[18:19], v5 offset:14848
    ds_read_b128 v[220:223], v254 offset:9216
    s_waitcnt lgkmcnt(6)
    v_mfma_f32_16x16x32_bf16 v[24:27], v[8:11], v[200:203], v[24:27]
    ds_read_b64_tr_b16 v[20:21], v5 offset:15360
    ds_read_b128 v[224:227], v254 offset:10240
    v_mfma_f32_16x16x32_bf16 v[28:31], v[8:11], v[204:207], v[28:31]
    ds_read_b64_tr_b16 v[22:23], v5 offset:15872
    ds_read_b128 v[228:231], v254 offset:11264
    s_waitcnt lgkmcnt(8)
    v_mfma_f32_16x16x32_bf16 v[32:35], v[12:15], v[200:203], v[32:35]
    ds_read_b64_tr_b16 v[8:9], v5 offset:16384
    v_mfma_f32_16x16x32_bf16 v[36:39], v[12:15], v[204:207], v[36:39]
    ds_read_b64_tr_b16 v[10:11], v5 offset:16896
    s_waitcnt lgkmcnt(7)
    v_mfma_f32_16x16x32_bf16 v[40:43], v[16:19], v[200:203], v[40:43]
    ds_read_b64_tr_b16 v[12:13], v5 offset:17408
    v_mfma_f32_16x16x32_bf16 v[44:47], v[16:19], v[204:207], v[44:47]
    ds_read_b64_tr_b16 v[14:15], v5 offset:17920
    s_waitcnt lgkmcnt(5)
    v_mfma_f32_16x16x32_bf16 v[48:51], v[20:23], v[200:203], v[48:51]
    ds_read_b64_tr_b16 v[16:17], v5 offset:18432
    v_mfma_f32_16x16x32_bf16 v[52:55], v[20:23], v[204:207], v[52:55]
    ds_read_b64_tr_b16 v[18:19], v5 offset:18944
    s_waitcnt lgkmcnt(4)
    v_mfma_f32_16x16x32_bf16 v[24:27], v[8:11], v[208:211], v[24:27]
    ds_read_b64_tr_b16 v[20:21], v5 offset:19456
    v_mfma_f32_16x16x32_bf16 v[28:31], v[8:11], v[212:215], v[28:31]
    ds_read_b64_tr_b16 v[22:23], v5 offset:19968
    s_waitcnt lgkmcnt(4)
    v_mfma_f32_16x16x32_bf16 v[32:35], v[12:15], v[208:211], v[32:35]
    ds_read_b64_tr_b16 v[8:9], v5 offset:20480
    v_mfma_f32_16x16x32_bf16 v[36:39], v[12:15], v[212:215], v[36:39]
    ds_read_b64_tr_b16 v[10:11], v5 offset:20992
    s_waitcnt lgkmcnt(4)
    v_mfma_f32_16x16x32_bf16 v[40:43], v[16:19], v[208:211], v[40:43]
    ds_read_b64_tr_b16 v[12:13], v5 offset:21504
    v_mfma_f32_16x16x32_bf16 v[44:47], v[16:19], v[212:215], v[44:47]
    ds_read_b64_tr_b16 v[14:15], v5 offset:22016
    s_waitcnt lgkmcnt(4)
    v_mfma_f32_16x16x32_bf16 v[48:51], v[20:23], v[208:211], v[48:51]
    ds_read_b64_tr_b16 v[16:17], v5 offset:22528
    v_mfma_f32_16x16x32_bf16 v[52:55], v[20:23], v[212:215], v[52:55]
    ds_read_b64_tr_b16 v[18:19], v5 offset:23040
    s_waitcnt lgkmcnt(4)
    v_mfma_f32_16x16x32_bf16 v[24:27], v[8:11], v[216:219], v[24:27]
    ds_read_b64_tr_b16 v[20:21], v5 offset:23552
    v_mfma_f32_16x16x32_bf16 v[28:31], v[8:11], v[220:223], v[28:31]
    ds_read_b64_tr_b16 v[22:23], v5 offset:24064
    s_waitcnt lgkmcnt(4)
    v_mfma_f32_16x16x32_bf16 v[32:35], v[12:15], v[216:219], v[32:35]
    s_barrier
    ds_read_b64_tr_b16 v[8:9], v4 offset:0
    ds_read_b128 v[232:235], v252 offset:20480
    v_mfma_f32_16x16x32_bf16 v[36:39], v[12:15], v[220:223], v[36:39]
    ds_read_b64_tr_b16 v[10:11], v4 offset:512
    ds_read_b128 v[236:239], v252 offset:21504
    s_waitcnt lgkmcnt(6)
    v_mfma_f32_16x16x32_bf16 v[40:43], v[16:19], v[216:219], v[40:43]
    ds_read_b64_tr_b16 v[12:13], v4 offset:1024
    ds_read_b128 v[240:243], v252 offset:22528
    v_mfma_f32_16x16x32_bf16 v[44:47], v[16:19], v[220:223], v[44:47]
    ds_read_b64_tr_b16 v[14:15], v4 offset:1536
    ds_read_b128 v[244:247], v252 offset:23552
    s_waitcnt lgkmcnt(8)
    v_mfma_f32_16x16x32_bf16 v[48:51], v[20:23], v[216:219], v[48:51]
    ds_read_b64_tr_b16 v[16:17], v4 offset:2048
    v_mfma_f32_16x16x32_bf16 v[52:55], v[20:23], v[220:223], v[52:55]
    ds_read_b64_tr_b16 v[18:19], v4 offset:2560
    s_waitcnt lgkmcnt(7)
    v_mfma_f32_16x16x32_bf16 v[24:27], v[8:11], v[224:227], v[24:27]
    ds_read_b64_tr_b16 v[20:21], v4 offset:3072
    v_mfma_f32_16x16x32_bf16 v[28:31], v[8:11], v[228:231], v[28:31]
    ds_read_b64_tr_b16 v[22:23], v4 offset:3584
    s_waitcnt lgkmcnt(5)
    v_mfma_f32_16x16x32_bf16 v[32:35], v[12:15], v[224:227], v[32:35]
    ds_read_b64_tr_b16 v[8:9], v4 offset:4096
    v_mfma_f32_16x16x32_bf16 v[36:39], v[12:15], v[228:231], v[36:39]
    ds_read_b64_tr_b16 v[10:11], v4 offset:4608
    s_waitcnt lgkmcnt(4)
    v_mfma_f32_16x16x32_bf16 v[40:43], v[16:19], v[224:227], v[40:43]
    ds_read_b64_tr_b16 v[12:13], v4 offset:5120
    v_mfma_f32_16x16x32_bf16 v[44:47], v[16:19], v[228:231], v[44:47]
    ds_read_b64_tr_b16 v[14:15], v4 offset:5632
    s_waitcnt lgkmcnt(4)
    v_mfma_f32_16x16x32_bf16 v[48:51], v[20:23], v[224:227], v[48:51]
    ds_read_b64_tr_b16 v[16:17], v4 offset:6144
    v_mfma_f32_16x16x32_bf16 v[52:55], v[20:23], v[228:231], v[52:55]
    ds_read_b64_tr_b16 v[18:19], v4 offset:6656
    s_waitcnt lgkmcnt(4)
    v_mfma_f32_16x16x32_bf16 v[24:27], v[8:11], v[232:235], v[24:27]
    ds_read_b64_tr_b16 v[20:21], v4 offset:7168
    v_mfma_f32_16x16x32_bf16 v[28:31], v[8:11], v[236:239], v[28:31]
    ds_read_b64_tr_b16 v[22:23], v4 offset:7680
    s_waitcnt lgkmcnt(4)
    v_mfma_f32_16x16x32_bf16 v[32:35], v[12:15], v[232:235], v[32:35]
    ds_read_b64_tr_b16 v[8:9], v4 offset:8192
    v_mfma_f32_16x16x32_bf16 v[36:39], v[12:15], v[236:239], v[36:39]
    ds_read_b64_tr_b16 v[10:11], v4 offset:8704
    s_waitcnt lgkmcnt(4)
    v_mfma_f32_16x16x32_bf16 v[40:43], v[16:19], v[232:235], v[40:43]
    ds_read_b64_tr_b16 v[12:13], v4 offset:9216
    v_mfma_f32_16x16x32_bf16 v[44:47], v[16:19], v[236:239], v[44:47]
    ds_read_b64_tr_b16 v[14:15], v4 offset:9728
    s_waitcnt lgkmcnt(4)
    v_mfma_f32_16x16x32_bf16 v[48:51], v[20:23], v[232:235], v[48:51]
    s_barrier
    ds_read_b64_tr_b16 v[16:17], v4 offset:10240
    v_mfma_f32_16x16x32_bf16 v[52:55], v[20:23], v[236:239], v[52:55]
    ds_read_b64_tr_b16 v[18:19], v4 offset:10752
    s_waitcnt lgkmcnt(4)
    v_mfma_f32_16x16x32_bf16 v[24:27], v[8:11], v[240:243], v[24:27]
    ds_read_b64_tr_b16 v[20:21], v4 offset:11264
    v_mfma_f32_16x16x32_bf16 v[28:31], v[8:11], v[244:247], v[28:31]
    ds_read_b64_tr_b16 v[22:23], v4 offset:11776
    s_waitcnt lgkmcnt(4)
    v_mfma_f32_16x16x32_bf16 v[32:35], v[12:15], v[240:243], v[32:35]
    ds_read_b64_tr_b16 v[8:9], v4 offset:12288
    v_mfma_f32_16x16x32_bf16 v[36:39], v[12:15], v[244:247], v[36:39]
    ds_read_b64_tr_b16 v[10:11], v4 offset:12800
    s_waitcnt lgkmcnt(4)
    v_mfma_f32_16x16x32_bf16 v[40:43], v[16:19], v[240:243], v[40:43]
    ds_read_b64_tr_b16 v[12:13], v4 offset:13312
    v_mfma_f32_16x16x32_bf16 v[44:47], v[16:19], v[244:247], v[44:47]
    ds_read_b64_tr_b16 v[14:15], v4 offset:13824
    s_waitcnt lgkmcnt(4)
    v_mfma_f32_16x16x32_bf16 v[48:51], v[20:23], v[240:243], v[48:51]
    ds_read_b64_tr_b16 v[16:17], v4 offset:14336
    v_mfma_f32_16x16x32_bf16 v[52:55], v[20:23], v[244:247], v[52:55]
    ds_read_b64_tr_b16 v[18:19], v4 offset:14848
    s_waitcnt lgkmcnt(4)
    v_mfma_f32_16x16x32_bf16 v[56:59], v[8:11], v[152:155], v[56:59]
    ds_read_b64_tr_b16 v[20:21], v4 offset:15360
    v_mfma_f32_16x16x32_bf16 v[60:63], v[8:11], v[156:159], v[60:63]
    ds_read_b64_tr_b16 v[22:23], v4 offset:15872
    s_waitcnt lgkmcnt(4)
    v_mfma_f32_16x16x32_bf16 v[64:67], v[12:15], v[152:155], v[64:67]
    ds_read_b64_tr_b16 v[8:9], v4 offset:16384
    v_mul_f32 v24, v24, v32
    v_mfma_f32_16x16x32_bf16 v[68:71], v[12:15], v[156:159], v[68:71]
    ds_read_b64_tr_b16 v[10:11], v4 offset:16896
    v_mul_f32 v25, v25, v33
    s_waitcnt lgkmcnt(4)
    v_mfma_f32_16x16x32_bf16 v[72:75], v[16:19], v[152:155], v[72:75]
    ds_read_b64_tr_b16 v[12:13], v4 offset:17408
    v_mul_f32 v26, v26, v34
    v_mfma_f32_16x16x32_bf16 v[76:79], v[16:19], v[156:159], v[76:79]
    ds_read_b64_tr_b16 v[14:15], v4 offset:17920
    v_mul_f32 v27, v27, v35
    s_waitcnt lgkmcnt(4)
    v_mfma_f32_16x16x32_bf16 v[80:83], v[20:23], v[152:155], v[80:83]
    ds_read_b64_tr_b16 v[16:17], v4 offset:18432
    v_cvt_pk_bf16_f32 v248, v24, v25
    v_mfma_f32_16x16x32_bf16 v[84:87], v[20:23], v[156:159], v[84:87]
    ds_read_b64_tr_b16 v[18:19], v4 offset:18944
    v_cvt_pk_bf16_f32 v249, v26, v27
    s_waitcnt lgkmcnt(4)
    v_mfma_f32_16x16x32_bf16 v[56:59], v[8:11], v[160:163], v[56:59]
    ds_read_b64_tr_b16 v[20:21], v4 offset:19456
    v_mul_f32 v40, v40, v48
    v_mfma_f32_16x16x32_bf16 v[60:63], v[8:11], v[164:167], v[60:63]
    ds_read_b64_tr_b16 v[22:23], v4 offset:19968
    v_mul_f32 v41, v41, v49
    s_waitcnt lgkmcnt(4)
    v_mfma_f32_16x16x32_bf16 v[64:67], v[12:15], v[160:163], v[64:67]
    s_barrier
    ds_read_b64_tr_b16 v[8:9], v4 offset:40960
    v_mul_f32 v42, v42, v50
    v_mfma_f32_16x16x32_bf16 v[68:71], v[12:15], v[164:167], v[68:71]
    ds_read_b64_tr_b16 v[10:11], v4 offset:41472
    v_mul_f32 v43, v43, v51
    s_waitcnt lgkmcnt(4)
    v_mfma_f32_16x16x32_bf16 v[72:75], v[16:19], v[160:163], v[72:75]
    ds_read_b64_tr_b16 v[12:13], v4 offset:41984
    v_cvt_pk_bf16_f32 v250, v40, v41
    v_mfma_f32_16x16x32_bf16 v[76:79], v[16:19], v[164:167], v[76:79]
    ds_read_b64_tr_b16 v[14:15], v4 offset:42496
    v_cvt_pk_bf16_f32 v251, v42, v43
    s_waitcnt lgkmcnt(4)
    v_mfma_f32_16x16x32_bf16 v[80:83], v[20:23], v[160:163], v[80:83]
    ds_read_b64_tr_b16 v[16:17], v4 offset:43008
    buffer_store_dwordx4 v[248:251], v7, s[36:39], s66 offen sc1
    s_add_u32 s66, s66, 16384
    v_mfma_f32_16x16x32_bf16 v[84:87], v[20:23], v[164:167], v[84:87]
    ds_read_b64_tr_b16 v[18:19], v4 offset:43520
    v_mul_f32 v28, v28, v36
    s_waitcnt lgkmcnt(4)
    v_mfma_f32_16x16x32_bf16 v[56:59], v[8:11], v[168:171], v[56:59]
    ds_read_b64_tr_b16 v[20:21], v4 offset:44032
    v_mul_f32 v29, v29, v37
    v_mfma_f32_16x16x32_bf16 v[60:63], v[8:11], v[172:175], v[60:63]
    ds_read_b64_tr_b16 v[22:23], v4 offset:44544
    v_mul_f32 v30, v30, v38
    s_waitcnt lgkmcnt(4)
    v_mfma_f32_16x16x32_bf16 v[64:67], v[12:15], v[168:171], v[64:67]
    ds_read_b64_tr_b16 v[8:9], v4 offset:45056
    v_mul_f32 v31, v31, v39
    v_mfma_f32_16x16x32_bf16 v[68:71], v[12:15], v[172:175], v[68:71]
    ds_read_b64_tr_b16 v[10:11], v4 offset:45568
    v_cvt_pk_bf16_f32 v248, v28, v29
    s_waitcnt lgkmcnt(4)
    v_mfma_f32_16x16x32_bf16 v[72:75], v[16:19], v[168:171], v[72:75]
    ds_read_b64_tr_b16 v[12:13], v4 offset:46080
    v_cvt_pk_bf16_f32 v249, v30, v31
    v_mfma_f32_16x16x32_bf16 v[76:79], v[16:19], v[172:175], v[76:79]
    ds_read_b64_tr_b16 v[14:15], v4 offset:46592
    v_mul_f32 v44, v44, v52
    s_waitcnt lgkmcnt(4)
    v_mfma_f32_16x16x32_bf16 v[80:83], v[20:23], v[168:171], v[80:83]
    ds_read_b64_tr_b16 v[16:17], v4 offset:47104
    v_mul_f32 v45, v45, v53
    v_mfma_f32_16x16x32_bf16 v[84:87], v[20:23], v[172:175], v[84:87]
    ds_read_b64_tr_b16 v[18:19], v4 offset:47616
    v_mul_f32 v46, v46, v54
    s_waitcnt lgkmcnt(4)
    v_mfma_f32_16x16x32_bf16 v[56:59], v[8:11], v[176:179], v[56:59]
    ds_read_b64_tr_b16 v[20:21], v4 offset:48128
    v_mul_f32 v47, v47, v55
    v_mfma_f32_16x16x32_bf16 v[60:63], v[8:11], v[180:183], v[60:63]
    ds_read_b64_tr_b16 v[22:23], v4 offset:48640
    v_cvt_pk_bf16_f32 v250, v44, v45
    s_waitcnt lgkmcnt(4)
    v_mfma_f32_16x16x32_bf16 v[64:67], v[12:15], v[176:179], v[64:67]
    ds_read_b64_tr_b16 v[8:9], v4 offset:49152
    v_cvt_pk_bf16_f32 v251, v46, v47
    v_mfma_f32_16x16x32_bf16 v[68:71], v[12:15], v[180:183], v[68:71]
    ds_read_b64_tr_b16 v[10:11], v4 offset:49664
    buffer_store_dwordx4 v[248:251], v7, s[36:39], s67 offen sc1
    s_add_u32 s67, s67, 16384
    s_waitcnt lgkmcnt(4)
    v_mfma_f32_16x16x32_bf16 v[72:75], v[16:19], v[176:179], v[72:75]
    ds_read_b64_tr_b16 v[12:13], v4 offset:50176
    v_mfma_f32_16x16x32_bf16 v[76:79], v[16:19], v[180:183], v[76:79]
    ds_read_b64_tr_b16 v[14:15], v4 offset:50688
    s_waitcnt lgkmcnt(4)
    v_mfma_f32_16x16x32_bf16 v[80:83], v[20:23], v[176:179], v[80:83]
    s_barrier
    ds_read_b64_tr_b16 v[16:17], v4 offset:51200
    v_mfma_f32_16x16x32_bf16 v[84:87], v[20:23], v[180:183], v[84:87]
    ds_read_b64_tr_b16 v[18:19], v4 offset:51712
    s_waitcnt lgkmcnt(4)
    v_mfma_f32_16x16x32_bf16 v[56:59], v[8:11], v[184:187], v[56:59]
    ds_read_b64_tr_b16 v[20:21], v4 offset:52224
    v_mfma_f32_16x16x32_bf16 v[60:63], v[8:11], v[188:191], v[60:63]
    ds_read_b64_tr_b16 v[22:23], v4 offset:52736
    s_waitcnt lgkmcnt(4)
    v_mfma_f32_16x16x32_bf16 v[64:67], v[12:15], v[184:187], v[64:67]
    ds_read_b64_tr_b16 v[8:9], v4 offset:53248
    v_mfma_f32_16x16x32_bf16 v[68:71], v[12:15], v[188:191], v[68:71]
    ds_read_b64_tr_b16 v[10:11], v4 offset:53760
    s_waitcnt lgkmcnt(4)
    v_mfma_f32_16x16x32_bf16 v[72:75], v[16:19], v[184:187], v[72:75]
    ds_read_b64_tr_b16 v[12:13], v4 offset:54272
    v_mfma_f32_16x16x32_bf16 v[76:79], v[16:19], v[188:191], v[76:79]
    ds_read_b64_tr_b16 v[14:15], v4 offset:54784
    s_waitcnt lgkmcnt(4)
    v_mfma_f32_16x16x32_bf16 v[80:83], v[20:23], v[184:187], v[80:83]
    ds_read_b64_tr_b16 v[16:17], v4 offset:55296
    v_mfma_f32_16x16x32_bf16 v[84:87], v[20:23], v[188:191], v[84:87]
    ds_read_b64_tr_b16 v[18:19], v4 offset:55808
    s_waitcnt lgkmcnt(4)
    v_mfma_f32_16x16x32_bf16 v[56:59], v[8:11], v[192:195], v[56:59]
    ds_read_b64_tr_b16 v[20:21], v4 offset:56320
    v_mfma_f32_16x16x32_bf16 v[60:63], v[8:11], v[196:199], v[60:63]
    ds_read_b64_tr_b16 v[22:23], v4 offset:56832
    s_waitcnt lgkmcnt(4)
    v_mfma_f32_16x16x32_bf16 v[64:67], v[12:15], v[192:195], v[64:67]
    ds_read_b64_tr_b16 v[8:9], v5 offset:0
    v_mfma_f32_16x16x32_bf16 v[68:71], v[12:15], v[196:199], v[68:71]
    ds_read_b64_tr_b16 v[10:11], v5 offset:512
    s_waitcnt lgkmcnt(4)
    v_mfma_f32_16x16x32_bf16 v[72:75], v[16:19], v[192:195], v[72:75]
    ds_read_b64_tr_b16 v[12:13], v5 offset:1024
    v_mfma_f32_16x16x32_bf16 v[76:79], v[16:19], v[196:199], v[76:79]
    ds_read_b64_tr_b16 v[14:15], v5 offset:1536
    s_waitcnt lgkmcnt(4)
    v_mfma_f32_16x16x32_bf16 v[80:83], v[20:23], v[192:195], v[80:83]
    ds_read_b64_tr_b16 v[16:17], v5 offset:2048
    v_mfma_f32_16x16x32_bf16 v[84:87], v[20:23], v[196:199], v[84:87]
    ds_read_b64_tr_b16 v[18:19], v5 offset:2560
    s_waitcnt lgkmcnt(4)
    v_mfma_f32_16x16x32_bf16 v[56:59], v[8:11], v[200:203], v[56:59]
    ds_read_b64_tr_b16 v[20:21], v5 offset:3072
    v_mfma_f32_16x16x32_bf16 v[60:63], v[8:11], v[204:207], v[60:63]
    ds_read_b64_tr_b16 v[22:23], v5 offset:3584
    s_waitcnt lgkmcnt(4)
    v_mfma_f32_16x16x32_bf16 v[64:67], v[12:15], v[200:203], v[64:67]
    s_barrier
    ds_read_b64_tr_b16 v[8:9], v5 offset:24576
    v_mfma_f32_16x16x32_bf16 v[68:71], v[12:15], v[204:207], v[68:71]
    ds_read_b64_tr_b16 v[10:11], v5 offset:25088
    s_waitcnt lgkmcnt(4)
    v_mfma_f32_16x16x32_bf16 v[72:75], v[16:19], v[200:203], v[72:75]
    ds_read_b64_tr_b16 v[12:13], v5 offset:25600
    v_mfma_f32_16x16x32_bf16 v[76:79], v[16:19], v[204:207], v[76:79]
    ds_read_b64_tr_b16 v[14:15], v5 offset:26112
    s_waitcnt lgkmcnt(4)
    v_mfma_f32_16x16x32_bf16 v[80:83], v[20:23], v[200:203], v[80:83]
    ds_read_b64_tr_b16 v[16:17], v5 offset:26624
    v_mfma_f32_16x16x32_bf16 v[84:87], v[20:23], v[204:207], v[84:87]
    ds_read_b64_tr_b16 v[18:19], v5 offset:27136
    s_waitcnt lgkmcnt(4)
    v_mfma_f32_16x16x32_bf16 v[56:59], v[8:11], v[208:211], v[56:59]
    ds_read_b64_tr_b16 v[20:21], v5 offset:27648
    v_mfma_f32_16x16x32_bf16 v[60:63], v[8:11], v[212:215], v[60:63]
    ds_read_b64_tr_b16 v[22:23], v5 offset:28160
    s_waitcnt lgkmcnt(4)
    v_mfma_f32_16x16x32_bf16 v[64:67], v[12:15], v[208:211], v[64:67]
    ds_read_b64_tr_b16 v[8:9], v5 offset:28672
    v_mfma_f32_16x16x32_bf16 v[68:71], v[12:15], v[212:215], v[68:71]
    ds_read_b64_tr_b16 v[10:11], v5 offset:29184
    s_waitcnt lgkmcnt(4)
    v_mfma_f32_16x16x32_bf16 v[72:75], v[16:19], v[208:211], v[72:75]
    ds_read_b64_tr_b16 v[12:13], v5 offset:29696
    v_mfma_f32_16x16x32_bf16 v[76:79], v[16:19], v[212:215], v[76:79]
    ds_read_b64_tr_b16 v[14:15], v5 offset:30208
    s_waitcnt lgkmcnt(4)
    v_mfma_f32_16x16x32_bf16 v[80:83], v[20:23], v[208:211], v[80:83]
    ds_read_b64_tr_b16 v[16:17], v5 offset:30720
    v_mfma_f32_16x16x32_bf16 v[84:87], v[20:23], v[212:215], v[84:87]
    ds_read_b64_tr_b16 v[18:19], v5 offset:31232
    s_waitcnt lgkmcnt(4)
    v_mfma_f32_16x16x32_bf16 v[56:59], v[8:11], v[216:219], v[56:59]
    ds_read_b64_tr_b16 v[20:21], v5 offset:31744
    v_mfma_f32_16x16x32_bf16 v[60:63], v[8:11], v[220:223], v[60:63]
    ds_read_b64_tr_b16 v[22:23], v5 offset:32256
    s_waitcnt lgkmcnt(4)
    v_mfma_f32_16x16x32_bf16 v[64:67], v[12:15], v[216:219], v[64:67]
    ds_read_b64_tr_b16 v[8:9], v5 offset:32768
    v_mfma_f32_16x16x32_bf16 v[68:71], v[12:15], v[220:223], v[68:71]
    ds_read_b64_tr_b16 v[10:11], v5 offset:33280
    s_waitcnt lgkmcnt(4)
    v_mfma_f32_16x16x32_bf16 v[72:75], v[16:19], v[216:219], v[72:75]
    ds_read_b64_tr_b16 v[12:13], v5 offset:33792
    v_mfma_f32_16x16x32_bf16 v[76:79], v[16:19], v[220:223], v[76:79]
    ds_read_b64_tr_b16 v[14:15], v5 offset:34304
    s_waitcnt lgkmcnt(4)
    v_mfma_f32_16x16x32_bf16 v[80:83], v[20:23], v[216:219], v[80:83]
    s_waitcnt vmcnt(0)
    s_barrier
    ds_read_b64_tr_b16 v[16:17], v5 offset:34816
    v_mfma_f32_16x16x32_bf16 v[84:87], v[20:23], v[220:223], v[84:87]
    ds_read_b64_tr_b16 v[18:19], v5 offset:35328
    s_waitcnt lgkmcnt(4)
    v_mfma_f32_16x16x32_bf16 v[56:59], v[8:11], v[224:227], v[56:59]
    ds_read_b64_tr_b16 v[20:21], v5 offset:35840
    v_mfma_f32_16x16x32_bf16 v[60:63], v[8:11], v[228:231], v[60:63]
    ds_read_b64_tr_b16 v[22:23], v5 offset:36352
    s_waitcnt lgkmcnt(4)
    v_mfma_f32_16x16x32_bf16 v[64:67], v[12:15], v[224:227], v[64:67]
    ds_read_b64_tr_b16 v[8:9], v5 offset:36864
    v_mfma_f32_16x16x32_bf16 v[68:71], v[12:15], v[228:231], v[68:71]
    ds_read_b64_tr_b16 v[10:11], v5 offset:37376
    s_waitcnt lgkmcnt(4)
    v_mfma_f32_16x16x32_bf16 v[72:75], v[16:19], v[224:227], v[72:75]
    ds_read_b64_tr_b16 v[12:13], v5 offset:37888
    v_mfma_f32_16x16x32_bf16 v[76:79], v[16:19], v[228:231], v[76:79]
    ds_read_b64_tr_b16 v[14:15], v5 offset:38400
    s_waitcnt lgkmcnt(4)
    v_mfma_f32_16x16x32_bf16 v[80:83], v[20:23], v[224:227], v[80:83]
    ds_read_b64_tr_b16 v[16:17], v5 offset:38912
    v_mfma_f32_16x16x32_bf16 v[84:87], v[20:23], v[228:231], v[84:87]
    ds_read_b64_tr_b16 v[18:19], v5 offset:39424
    s_waitcnt lgkmcnt(4)
    v_mfma_f32_16x16x32_bf16 v[56:59], v[8:11], v[232:235], v[56:59]
    ds_read_b64_tr_b16 v[20:21], v5 offset:39936
    v_mfma_f32_16x16x32_bf16 v[60:63], v[8:11], v[236:239], v[60:63]
    ds_read_b64_tr_b16 v[22:23], v5 offset:40448
    s_waitcnt lgkmcnt(4)
    v_mfma_f32_16x16x32_bf16 v[64:67], v[12:15], v[232:235], v[64:67]
    ds_read_b64_tr_b16 v[8:9], v5 offset:40960
    v_mfma_f32_16x16x32_bf16 v[68:71], v[12:15], v[236:239], v[68:71]
    ds_read_b64_tr_b16 v[10:11], v5 offset:41472
    s_waitcnt lgkmcnt(4)
    v_mfma_f32_16x16x32_bf16 v[72:75], v[16:19], v[232:235], v[72:75]
    ds_read_b64_tr_b16 v[12:13], v5 offset:41984
    v_mfma_f32_16x16x32_bf16 v[76:79], v[16:19], v[236:239], v[76:79]
    ds_read_b64_tr_b16 v[14:15], v5 offset:42496
    s_waitcnt lgkmcnt(4)
    v_mfma_f32_16x16x32_bf16 v[80:83], v[20:23], v[232:235], v[80:83]
    ds_read_b64_tr_b16 v[16:17], v5 offset:43008
    v_mfma_f32_16x16x32_bf16 v[84:87], v[20:23], v[236:239], v[84:87]
    ds_read_b64_tr_b16 v[18:19], v5 offset:43520
    s_waitcnt lgkmcnt(4)
    v_mfma_f32_16x16x32_bf16 v[56:59], v[8:11], v[240:243], v[56:59]
    ds_read_b64_tr_b16 v[20:21], v5 offset:44032
    v_mfma_f32_16x16x32_bf16 v[60:63], v[8:11], v[244:247], v[60:63]
    ds_read_b64_tr_b16 v[22:23], v5 offset:44544
    s_waitcnt lgkmcnt(4)
    v_mfma_f32_16x16x32_bf16 v[64:67], v[12:15], v[240:243], v[64:67]
    s_barrier
    ds_read_b64_tr_b16 v[8:9], v4 offset:20480
    v_mfma_f32_16x16x32_bf16 v[68:71], v[12:15], v[244:247], v[68:71]
    ds_read_b64_tr_b16 v[10:11], v4 offset:20992
    s_waitcnt lgkmcnt(4)
    v_mfma_f32_16x16x32_bf16 v[72:75], v[16:19], v[240:243], v[72:75]
    ds_read_b64_tr_b16 v[12:13], v4 offset:21504
    v_mfma_f32_16x16x32_bf16 v[76:79], v[16:19], v[244:247], v[76:79]
    ds_read_b64_tr_b16 v[14:15], v4 offset:22016
    s_waitcnt lgkmcnt(4)
    v_mfma_f32_16x16x32_bf16 v[80:83], v[20:23], v[240:243], v[80:83]
    ds_read_b64_tr_b16 v[16:17], v4 offset:22528
    v_mfma_f32_16x16x32_bf16 v[84:87], v[20:23], v[244:247], v[84:87]
    ds_read_b64_tr_b16 v[18:19], v4 offset:23040
    s_waitcnt lgkmcnt(4)
    v_mfma_f32_16x16x32_bf16 v[24:27], v[8:11], v[88:91], 0
    ds_read_b64_tr_b16 v[20:21], v4 offset:23552
    v_mfma_f32_16x16x32_bf16 v[28:31], v[8:11], v[92:95], 0
    ds_read_b64_tr_b16 v[22:23], v4 offset:24064
    s_waitcnt lgkmcnt(4)
    v_mfma_f32_16x16x32_bf16 v[32:35], v[12:15], v[88:91], 0
    ds_read_b64_tr_b16 v[8:9], v4 offset:24576
    v_mul_f32 v56, v56, v64
    v_mfma_f32_16x16x32_bf16 v[36:39], v[12:15], v[92:95], 0
    ds_read_b64_tr_b16 v[10:11], v4 offset:25088
    v_mul_f32 v57, v57, v65
    s_waitcnt lgkmcnt(4)
    v_mfma_f32_16x16x32_bf16 v[40:43], v[16:19], v[88:91], 0
    ds_read_b64_tr_b16 v[12:13], v4 offset:25600
    v_mul_f32 v58, v58, v66
    v_mfma_f32_16x16x32_bf16 v[44:47], v[16:19], v[92:95], 0
    ds_read_b64_tr_b16 v[14:15], v4 offset:26112
    v_mul_f32 v59, v59, v67
    s_waitcnt lgkmcnt(4)
    v_mfma_f32_16x16x32_bf16 v[48:51], v[20:23], v[88:91], 0
    ds_read_b64_tr_b16 v[16:17], v4 offset:26624
    v_cvt_pk_bf16_f32 v248, v56, v57
    v_mfma_f32_16x16x32_bf16 v[52:55], v[20:23], v[92:95], 0
    ds_read_b64_tr_b16 v[18:19], v4 offset:27136
    v_cvt_pk_bf16_f32 v249, v58, v59
    s_waitcnt lgkmcnt(4)
    v_mfma_f32_16x16x32_bf16 v[24:27], v[8:11], v[96:99], v[24:27]
    ds_read_b64_tr_b16 v[20:21], v4 offset:27648
    v_mul_f32 v72, v72, v80
    v_mfma_f32_16x16x32_bf16 v[28:31], v[8:11], v[100:103], v[28:31]
    ds_read_b64_tr_b16 v[22:23], v4 offset:28160
    v_mul_f32 v73, v73, v81
    s_waitcnt lgkmcnt(4)
    v_mfma_f32_16x16x32_bf16 v[32:35], v[12:15], v[96:99], v[32:35]
    ds_read_b64_tr_b16 v[8:9], v4 offset:28672
    v_mul_f32 v74, v74, v82
    v_mfma_f32_16x16x32_bf16 v[36:39], v[12:15], v[100:103], v[36:39]
    ds_read_b64_tr_b16 v[10:11], v4 offset:29184
    v_mul_f32 v75, v75, v83
    s_waitcnt lgkmcnt(4)
    v_mfma_f32_16x16x32_bf16 v[40:43], v[16:19], v[96:99], v[40:43]
    ds_read_b64_tr_b16 v[12:13], v4 offset:29696
    v_cvt_pk_bf16_f32 v250, v72, v73
    v_mfma_f32_16x16x32_bf16 v[44:47], v[16:19], v[100:103], v[44:47]
    ds_read_b64_tr_b16 v[14:15], v4 offset:30208
    v_cvt_pk_bf16_f32 v251, v74, v75
    s_waitcnt lgkmcnt(4)
    v_mfma_f32_16x16x32_bf16 v[48:51], v[20:23], v[96:99], v[48:51]
    s_barrier
    ds_read_b64_tr_b16 v[16:17], v4 offset:30720
    buffer_store_dwordx4 v[248:251], v7, s[36:39], s66 offen sc1
    s_add_u32 s66, s66, 16384
    v_mfma_f32_16x16x32_bf16 v[52:55], v[20:23], v[100:103], v[52:55]
    ds_read_b64_tr_b16 v[18:19], v4 offset:31232
    v_mul_f32 v60, v60, v68
    s_waitcnt lgkmcnt(4)
    v_mfma_f32_16x16x32_bf16 v[24:27], v[8:11], v[104:107], v[24:27]
    ds_read_b64_tr_b16 v[20:21], v4 offset:31744
    v_mul_f32 v61, v61, v69
    v_mfma_f32_16x16x32_bf16 v[28:31], v[8:11], v[108:111], v[28:31]
    ds_read_b64_tr_b16 v[22:23], v4 offset:32256
    v_mul_f32 v62, v62, v70
    s_waitcnt lgkmcnt(4)
    v_mfma_f32_16x16x32_bf16 v[32:35], v[12:15], v[104:107], v[32:35]
    ds_read_b64_tr_b16 v[8:9], v4 offset:32768
    v_mul_f32 v63, v63, v71
    v_mfma_f32_16x16x32_bf16 v[36:39], v[12:15], v[108:111], v[36:39]
    ds_read_b64_tr_b16 v[10:11], v4 offset:33280
    v_cvt_pk_bf16_f32 v248, v60, v61
    s_waitcnt lgkmcnt(4)
    v_mfma_f32_16x16x32_bf16 v[40:43], v[16:19], v[104:107], v[40:43]
    ds_read_b64_tr_b16 v[12:13], v4 offset:33792
    v_cvt_pk_bf16_f32 v249, v62, v63
    v_mfma_f32_16x16x32_bf16 v[44:47], v[16:19], v[108:111], v[44:47]
    ds_read_b64_tr_b16 v[14:15], v4 offset:34304
    v_mul_f32 v76, v76, v84
    s_waitcnt lgkmcnt(4)
    v_mfma_f32_16x16x32_bf16 v[48:51], v[20:23], v[104:107], v[48:51]
    ds_read_b64_tr_b16 v[16:17], v4 offset:34816
    v_mul_f32 v77, v77, v85
    v_mfma_f32_16x16x32_bf16 v[52:55], v[20:23], v[108:111], v[52:55]
    ds_read_b64_tr_b16 v[18:19], v4 offset:35328
    v_mul_f32 v78, v78, v86
    s_waitcnt lgkmcnt(4)
    v_mfma_f32_16x16x32_bf16 v[24:27], v[8:11], v[112:115], v[24:27]
    ds_read_b64_tr_b16 v[20:21], v4 offset:35840
    v_mul_f32 v79, v79, v87
    v_mfma_f32_16x16x32_bf16 v[28:31], v[8:11], v[116:119], v[28:31]
    ds_read_b64_tr_b16 v[22:23], v4 offset:36352
    v_cvt_pk_bf16_f32 v250, v76, v77
    s_waitcnt lgkmcnt(4)
    v_mfma_f32_16x16x32_bf16 v[32:35], v[12:15], v[112:115], v[32:35]
    ds_read_b64_tr_b16 v[8:9], v4 offset:36864
    v_cvt_pk_bf16_f32 v251, v78, v79
    v_mfma_f32_16x16x32_bf16 v[36:39], v[12:15], v[116:119], v[36:39]
    ds_read_b64_tr_b16 v[10:11], v4 offset:37376
    buffer_store_dwordx4 v[248:251], v7, s[36:39], s67 offen sc1
    s_add_u32 s67, s67, 16384
    s_waitcnt lgkmcnt(4)
    v_mfma_f32_16x16x32_bf16 v[40:43], v[16:19], v[112:115], v[40:43]
    ds_read_b64_tr_b16 v[12:13], v4 offset:37888
    v_mfma_f32_16x16x32_bf16 v[44:47], v[16:19], v[116:119], v[44:47]
    ds_read_b64_tr_b16 v[14:15], v4 offset:38400
    s_waitcnt lgkmcnt(4)
    v_mfma_f32_16x16x32_bf16 v[48:51], v[20:23], v[112:115], v[48:51]
    ds_read_b64_tr_b16 v[16:17], v4 offset:38912
    v_mfma_f32_16x16x32_bf16 v[52:55], v[20:23], v[116:119], v[52:55]
    ds_read_b64_tr_b16 v[18:19], v4 offset:39424
    s_waitcnt lgkmcnt(4)
    v_mfma_f32_16x16x32_bf16 v[24:27], v[8:11], v[120:123], v[24:27]
    ds_read_b64_tr_b16 v[20:21], v4 offset:39936
    v_mfma_f32_16x16x32_bf16 v[28:31], v[8:11], v[124:127], v[28:31]
    ds_read_b64_tr_b16 v[22:23], v4 offset:40448
    s_waitcnt lgkmcnt(4)
    v_mfma_f32_16x16x32_bf16 v[32:35], v[12:15], v[120:123], v[32:35]
    s_barrier
    ds_read_b64_tr_b16 v[8:9], v5 offset:4096
    v_mfma_f32_16x16x32_bf16 v[36:39], v[12:15], v[124:127], v[36:39]
    ds_read_b64_tr_b16 v[10:11], v5 offset:4608
    s_waitcnt lgkmcnt(4)
    v_mfma_f32_16x16x32_bf16 v[40:43], v[16:19], v[120:123], v[40:43]
    ds_read_b64_tr_b16 v[12:13], v5 offset:5120
    v_mfma_f32_16x16x32_bf16 v[44:47], v[16:19], v[124:127], v[44:47]
    ds_read_b64_tr_b16 v[14:15], v5 offset:5632
    s_waitcnt lgkmcnt(4)
    v_mfma_f32_16x16x32_bf16 v[48:51], v[20:23], v[120:123], v[48:51]
    ds_read_b64_tr_b16 v[16:17], v5 offset:6144
    v_mfma_f32_16x16x32_bf16 v[52:55], v[20:23], v[124:127], v[52:55]
    ds_read_b64_tr_b16 v[18:19], v5 offset:6656
    s_waitcnt lgkmcnt(4)
    v_mfma_f32_16x16x32_bf16 v[24:27], v[8:11], v[128:131], v[24:27]
    ds_read_b64_tr_b16 v[20:21], v5 offset:7168
    v_mfma_f32_16x16x32_bf16 v[28:31], v[8:11], v[132:135], v[28:31]
    ds_read_b64_tr_b16 v[22:23], v5 offset:7680
    s_waitcnt lgkmcnt(4)
    v_mfma_f32_16x16x32_bf16 v[32:35], v[12:15], v[128:131], v[32:35]
    ds_read_b64_tr_b16 v[8:9], v5 offset:8192
    v_mfma_f32_16x16x32_bf16 v[36:39], v[12:15], v[132:135], v[36:39]
    ds_read_b64_tr_b16 v[10:11], v5 offset:8704
    s_waitcnt lgkmcnt(4)
    v_mfma_f32_16x16x32_bf16 v[40:43], v[16:19], v[128:131], v[40:43]
    ds_read_b64_tr_b16 v[12:13], v5 offset:9216
    v_mfma_f32_16x16x32_bf16 v[44:47], v[16:19], v[132:135], v[44:47]
    ds_read_b64_tr_b16 v[14:15], v5 offset:9728
    s_waitcnt lgkmcnt(4)
    v_mfma_f32_16x16x32_bf16 v[48:51], v[20:23], v[128:131], v[48:51]
    ds_read_b64_tr_b16 v[16:17], v5 offset:10240
    v_mfma_f32_16x16x32_bf16 v[52:55], v[20:23], v[132:135], v[52:55]
    ds_read_b64_tr_b16 v[18:19], v5 offset:10752
    s_waitcnt lgkmcnt(4)
    v_mfma_f32_16x16x32_bf16 v[24:27], v[8:11], v[136:139], v[24:27]
    ds_read_b64_tr_b16 v[20:21], v5 offset:11264
    v_mfma_f32_16x16x32_bf16 v[28:31], v[8:11], v[140:143], v[28:31]
    ds_read_b64_tr_b16 v[22:23], v5 offset:11776
    s_waitcnt lgkmcnt(4)
    v_mfma_f32_16x16x32_bf16 v[32:35], v[12:15], v[136:139], v[32:35]
    ds_read_b64_tr_b16 v[8:9], v5 offset:12288
    v_mfma_f32_16x16x32_bf16 v[36:39], v[12:15], v[140:143], v[36:39]
    ds_read_b64_tr_b16 v[10:11], v5 offset:12800
    s_waitcnt lgkmcnt(4)
    v_mfma_f32_16x16x32_bf16 v[40:43], v[16:19], v[136:139], v[40:43]
    ds_read_b64_tr_b16 v[12:13], v5 offset:13312
    v_mfma_f32_16x16x32_bf16 v[44:47], v[16:19], v[140:143], v[44:47]
    ds_read_b64_tr_b16 v[14:15], v5 offset:13824
    s_waitcnt lgkmcnt(4)
    v_mfma_f32_16x16x32_bf16 v[48:51], v[20:23], v[136:139], v[48:51]
    s_barrier
    ds_read_b64_tr_b16 v[16:17], v5 offset:14336
    v_mfma_f32_16x16x32_bf16 v[52:55], v[20:23], v[140:143], v[52:55]
    ds_read_b64_tr_b16 v[18:19], v5 offset:14848
    s_waitcnt lgkmcnt(4)
    v_mfma_f32_16x16x32_bf16 v[24:27], v[8:11], v[144:147], v[24:27]
    ds_read_b64_tr_b16 v[20:21], v5 offset:15360
    v_mfma_f32_16x16x32_bf16 v[28:31], v[8:11], v[148:151], v[28:31]
    ds_read_b64_tr_b16 v[22:23], v5 offset:15872
    s_waitcnt lgkmcnt(4)
    v_mfma_f32_16x16x32_bf16 v[32:35], v[12:15], v[144:147], v[32:35]
    ds_read_b64_tr_b16 v[8:9], v5 offset:16384
    v_mfma_f32_16x16x32_bf16 v[36:39], v[12:15], v[148:151], v[36:39]
    ds_read_b64_tr_b16 v[10:11], v5 offset:16896
    s_waitcnt lgkmcnt(4)
    v_mfma_f32_16x16x32_bf16 v[40:43], v[16:19], v[144:147], v[40:43]
    ds_read_b64_tr_b16 v[12:13], v5 offset:17408
    v_mfma_f32_16x16x32_bf16 v[44:47], v[16:19], v[148:151], v[44:47]
    ds_read_b64_tr_b16 v[14:15], v5 offset:17920
    s_waitcnt lgkmcnt(4)
    v_mfma_f32_16x16x32_bf16 v[48:51], v[20:23], v[144:147], v[48:51]
    ds_read_b64_tr_b16 v[16:17], v5 offset:18432
    v_mfma_f32_16x16x32_bf16 v[52:55], v[20:23], v[148:151], v[52:55]
    ds_read_b64_tr_b16 v[18:19], v5 offset:18944
    s_waitcnt lgkmcnt(4)
    v_mfma_f32_16x16x32_bf16 v[24:27], v[8:11], v[152:155], v[24:27]
    ds_read_b64_tr_b16 v[20:21], v5 offset:19456
    v_mfma_f32_16x16x32_bf16 v[28:31], v[8:11], v[156:159], v[28:31]
    ds_read_b64_tr_b16 v[22:23], v5 offset:19968
    s_waitcnt lgkmcnt(4)
    v_mfma_f32_16x16x32_bf16 v[32:35], v[12:15], v[152:155], v[32:35]
    ds_read_b64_tr_b16 v[8:9], v5 offset:20480
    v_mfma_f32_16x16x32_bf16 v[36:39], v[12:15], v[156:159], v[36:39]
    ds_read_b64_tr_b16 v[10:11], v5 offset:20992
    s_waitcnt lgkmcnt(4)
    v_mfma_f32_16x16x32_bf16 v[40:43], v[16:19], v[152:155], v[40:43]
    ds_read_b64_tr_b16 v[12:13], v5 offset:21504
    v_mfma_f32_16x16x32_bf16 v[44:47], v[16:19], v[156:159], v[44:47]
    ds_read_b64_tr_b16 v[14:15], v5 offset:22016
    s_waitcnt lgkmcnt(4)
    v_mfma_f32_16x16x32_bf16 v[48:51], v[20:23], v[152:155], v[48:51]
    ds_read_b64_tr_b16 v[16:17], v5 offset:22528
    v_mfma_f32_16x16x32_bf16 v[52:55], v[20:23], v[156:159], v[52:55]
    ds_read_b64_tr_b16 v[18:19], v5 offset:23040
    s_waitcnt lgkmcnt(4)
    v_mfma_f32_16x16x32_bf16 v[24:27], v[8:11], v[160:163], v[24:27]
    ds_read_b64_tr_b16 v[20:21], v5 offset:23552
    v_mfma_f32_16x16x32_bf16 v[28:31], v[8:11], v[164:167], v[28:31]
    ds_read_b64_tr_b16 v[22:23], v5 offset:24064
    s_waitcnt lgkmcnt(4)
    v_mfma_f32_16x16x32_bf16 v[32:35], v[12:15], v[160:163], v[32:35]
    s_waitcnt vmcnt(0)
    s_barrier
    ds_read_b64_tr_b16 v[8:9], v4 offset:0
    v_mfma_f32_16x16x32_bf16 v[36:39], v[12:15], v[164:167], v[36:39]
    ds_read_b64_tr_b16 v[10:11], v4 offset:512
    s_waitcnt lgkmcnt(4)
    v_mfma_f32_16x16x32_bf16 v[40:43], v[16:19], v[160:163], v[40:43]
    ds_read_b64_tr_b16 v[12:13], v4 offset:1024
    v_mfma_f32_16x16x32_bf16 v[44:47], v[16:19], v[164:167], v[44:47]
    ds_read_b64_tr_b16 v[14:15], v4 offset:1536
    s_waitcnt lgkmcnt(4)
    v_mfma_f32_16x16x32_bf16 v[48:51], v[20:23], v[160:163], v[48:51]
    ds_read_b64_tr_b16 v[16:17], v4 offset:2048
    v_mfma_f32_16x16x32_bf16 v[52:55], v[20:23], v[164:167], v[52:55]
    ds_read_b64_tr_b16 v[18:19], v4 offset:2560
    s_waitcnt lgkmcnt(4)
    v_mfma_f32_16x16x32_bf16 v[24:27], v[8:11], v[168:171], v[24:27]
    ds_read_b64_tr_b16 v[20:21], v4 offset:3072
    v_mfma_f32_16x16x32_bf16 v[28:31], v[8:11], v[172:175], v[28:31]
    ds_read_b64_tr_b16 v[22:23], v4 offset:3584
    s_waitcnt lgkmcnt(4)
    v_mfma_f32_16x16x32_bf16 v[32:35], v[12:15], v[168:171], v[32:35]
    ds_read_b64_tr_b16 v[8:9], v4 offset:4096
    v_mfma_f32_16x16x32_bf16 v[36:39], v[12:15], v[172:175], v[36:39]
    ds_read_b64_tr_b16 v[10:11], v4 offset:4608
    s_waitcnt lgkmcnt(4)
    v_mfma_f32_16x16x32_bf16 v[40:43], v[16:19], v[168:171], v[40:43]
    ds_read_b64_tr_b16 v[12:13], v4 offset:5120
    v_mfma_f32_16x16x32_bf16 v[44:47], v[16:19], v[172:175], v[44:47]
    ds_read_b64_tr_b16 v[14:15], v4 offset:5632
    s_waitcnt lgkmcnt(4)
    v_mfma_f32_16x16x32_bf16 v[48:51], v[20:23], v[168:171], v[48:51]
    ds_read_b64_tr_b16 v[16:17], v4 offset:6144
    v_mfma_f32_16x16x32_bf16 v[52:55], v[20:23], v[172:175], v[52:55]
    ds_read_b64_tr_b16 v[18:19], v4 offset:6656
    s_waitcnt lgkmcnt(4)
    v_mfma_f32_16x16x32_bf16 v[24:27], v[8:11], v[176:179], v[24:27]
    ds_read_b64_tr_b16 v[20:21], v4 offset:7168
    v_mfma_f32_16x16x32_bf16 v[28:31], v[8:11], v[180:183], v[28:31]
    ds_read_b64_tr_b16 v[22:23], v4 offset:7680
    s_waitcnt lgkmcnt(4)
    v_mfma_f32_16x16x32_bf16 v[32:35], v[12:15], v[176:179], v[32:35]
    ds_read_b64_tr_b16 v[8:9], v4 offset:8192
    v_mfma_f32_16x16x32_bf16 v[36:39], v[12:15], v[180:183], v[36:39]
    ds_read_b64_tr_b16 v[10:11], v4 offset:8704
    s_waitcnt lgkmcnt(4)
    v_mfma_f32_16x16x32_bf16 v[40:43], v[16:19], v[176:179], v[40:43]
    ds_read_b64_tr_b16 v[12:13], v4 offset:9216
    v_mfma_f32_16x16x32_bf16 v[44:47], v[16:19], v[180:183], v[44:47]
    ds_read_b64_tr_b16 v[14:15], v4 offset:9728
    s_waitcnt lgkmcnt(4)
    v_mfma_f32_16x16x32_bf16 v[48:51], v[20:23], v[176:179], v[48:51]
    s_barrier
    ds_read_b64_tr_b16 v[16:17], v4 offset:10240
    v_mfma_f32_16x16x32_bf16 v[52:55], v[20:23], v[180:183], v[52:55]
    ds_read_b64_tr_b16 v[18:19], v4 offset:10752
    s_add_u32 s74, s70, s86
    buffer_load_dwordx4 v[88:91], v7, s[36:39], s74 offen offset:0 sc1
    s_waitcnt lgkmcnt(4)
    v_mfma_f32_16x16x32_bf16 v[24:27], v[8:11], v[184:187], v[24:27]
    ds_read_b64_tr_b16 v[20:21], v4 offset:11264
    v_mfma_f32_16x16x32_bf16 v[28:31], v[8:11], v[188:191], v[28:31]
    ds_read_b64_tr_b16 v[22:23], v4 offset:11776
    s_waitcnt lgkmcnt(4)
    v_mfma_f32_16x16x32_bf16 v[32:35], v[12:15], v[184:187], v[32:35]
    ds_read_b64_tr_b16 v[8:9], v4 offset:12288
    v_mfma_f32_16x16x32_bf16 v[36:39], v[12:15], v[188:191], v[36:39]
    ds_read_b64_tr_b16 v[10:11], v4 offset:12800
    s_add_u32 s75, s71, s86
    buffer_load_dwordx4 v[92:95], v7, s[36:39], s75 offen offset:0 sc1
    s_waitcnt lgkmcnt(4)
    v_mfma_f32_16x16x32_bf16 v[40:43], v[16:19], v[184:187], v[40:43]
    ds_read_b64_tr_b16 v[12:13], v4 offset:13312
    v_mfma_f32_16x16x32_bf16 v[44:47], v[16:19], v[188:191], v[44:47]
    ds_read_b64_tr_b16 v[14:15], v4 offset:13824
    s_waitcnt lgkmcnt(4)
    v_mfma_f32_16x16x32_bf16 v[48:51], v[20:23], v[184:187], v[48:51]
    ds_read_b64_tr_b16 v[16:17], v4 offset:14336
    v_mfma_f32_16x16x32_bf16 v[52:55], v[20:23], v[188:191], v[52:55]
    ds_read_b64_tr_b16 v[18:19], v4 offset:14848
    s_waitcnt lgkmcnt(4)
    v_mfma_f32_16x16x32_bf16 v[24:27], v[8:11], v[192:195], v[24:27]
    ds_read_b64_tr_b16 v[20:21], v4 offset:15360
    v_mfma_f32_16x16x32_bf16 v[28:31], v[8:11], v[196:199], v[28:31]
    ds_read_b64_tr_b16 v[22:23], v4 offset:15872
    buffer_load_dwordx4 v[96:99], v7, s[36:39], s74 offen offset:2048 sc1
    s_waitcnt lgkmcnt(4)
    v_mfma_f32_16x16x32_bf16 v[32:35], v[12:15], v[192:195], v[32:35]
    ds_read_b64_tr_b16 v[8:9], v4 offset:16384
    v_mfma_f32_16x16x32_bf16 v[36:39], v[12:15], v[196:199], v[36:39]
    ds_read_b64_tr_b16 v[10:11], v4 offset:16896
    s_waitcnt lgkmcnt(4)
    v_mfma_f32_16x16x32_bf16 v[40:43], v[16:19], v[192:195], v[40:43]
    ds_read_b64_tr_b16 v[12:13], v4 offset:17408
    v_mfma_f32_16x16x32_bf16 v[44:47], v[16:19], v[196:199], v[44:47]
    ds_read_b64_tr_b16 v[14:15], v4 offset:17920
    buffer_load_dwordx4 v[100:103], v7, s[36:39], s75 offen offset:2048 sc1
    s_waitcnt lgkmcnt(4)
    v_mfma_f32_16x16x32_bf16 v[48:51], v[20:23], v[192:195], v[48:51]
    ds_read_b64_tr_b16 v[16:17], v4 offset:18432
    v_mfma_f32_16x16x32_bf16 v[52:55], v[20:23], v[196:199], v[52:55]
    ds_read_b64_tr_b16 v[18:19], v4 offset:18944
    s_waitcnt lgkmcnt(4)
    v_mfma_f32_16x16x32_bf16 v[24:27], v[8:11], v[200:203], v[24:27]
    ds_read_b64_tr_b16 v[20:21], v4 offset:19456
    v_mfma_f32_16x16x32_bf16 v[28:31], v[8:11], v[204:207], v[28:31]
    ds_read_b64_tr_b16 v[22:23], v4 offset:19968
    s_waitcnt lgkmcnt(4)
    v_mfma_f32_16x16x32_bf16 v[32:35], v[12:15], v[200:203], v[32:35]
    s_barrier
    ds_read_b64_tr_b16 v[8:9], v5 offset:45056
    v_mfma_f32_16x16x32_bf16 v[36:39], v[12:15], v[204:207], v[36:39]
    ds_read_b64_tr_b16 v[10:11], v5 offset:45568
    s_add_u32 s74, s70, s87
    buffer_load_dwordx4 v[104:107], v7, s[36:39], s74 offen offset:0 sc1
    s_waitcnt lgkmcnt(4)
    v_mfma_f32_16x16x32_bf16 v[40:43], v[16:19], v[200:203], v[40:43]
    ds_read_b64_tr_b16 v[12:13], v5 offset:46080
    v_mfma_f32_16x16x32_bf16 v[44:47], v[16:19], v[204:207], v[44:47]
    ds_read_b64_tr_b16 v[14:15], v5 offset:46592
    s_waitcnt lgkmcnt(4)
    v_mfma_f32_16x16x32_bf16 v[48:51], v[20:23], v[200:203], v[48:51]
    ds_read_b64_tr_b16 v[16:17], v5 offset:47104
    v_mfma_f32_16x16x32_bf16 v[52:55], v[20:23], v[204:207], v[52:55]
    ds_read_b64_tr_b16 v[18:19], v5 offset:47616
    s_add_u32 s75, s71, s87
    buffer_load_dwordx4 v[108:111], v7, s[36:39], s75 offen offset:0 sc1
    s_waitcnt lgkmcnt(4)
    v_mfma_f32_16x16x32_bf16 v[24:27], v[8:11], v[208:211], v[24:27]
    ds_read_b64_tr_b16 v[20:21], v5 offset:48128
    v_mfma_f32_16x16x32_bf16 v[28:31], v[8:11], v[212:215], v[28:31]
    ds_read_b64_tr_b16 v[22:23], v5 offset:48640
    s_waitcnt lgkmcnt(4)
    v_mfma_f32_16x16x32_bf16 v[32:35], v[12:15], v[208:211], v[32:35]
    ds_read_b64_tr_b16 v[8:9], v5 offset:49152
    v_mfma_f32_16x16x32_bf16 v[36:39], v[12:15], v[212:215], v[36:39]
    ds_read_b64_tr_b16 v[10:11], v5 offset:49664
    s_waitcnt lgkmcnt(4)
    v_mfma_f32_16x16x32_bf16 v[40:43], v[16:19], v[208:211], v[40:43]
    ds_read_b64_tr_b16 v[12:13], v5 offset:50176
    v_mfma_f32_16x16x32_bf16 v[44:47], v[16:19], v[212:215], v[44:47]
    ds_read_b64_tr_b16 v[14:15], v5 offset:50688
    buffer_load_dwordx4 v[112:115], v7, s[36:39], s74 offen offset:2048 sc1
    s_waitcnt lgkmcnt(4)
    v_mfma_f32_16x16x32_bf16 v[48:51], v[20:23], v[208:211], v[48:51]
    ds_read_b64_tr_b16 v[16:17], v5 offset:51200
    v_mfma_f32_16x16x32_bf16 v[52:55], v[20:23], v[212:215], v[52:55]
    ds_read_b64_tr_b16 v[18:19], v5 offset:51712
    s_waitcnt lgkmcnt(4)
    v_mfma_f32_16x16x32_bf16 v[24:27], v[8:11], v[216:219], v[24:27]
    ds_read_b64_tr_b16 v[20:21], v5 offset:52224
    v_mfma_f32_16x16x32_bf16 v[28:31], v[8:11], v[220:223], v[28:31]
    ds_read_b64_tr_b16 v[22:23], v5 offset:52736
    buffer_load_dwordx4 v[116:119], v7, s[36:39], s75 offen offset:2048 sc1
    s_waitcnt lgkmcnt(4)
    v_mfma_f32_16x16x32_bf16 v[32:35], v[12:15], v[216:219], v[32:35]
    ds_read_b64_tr_b16 v[8:9], v5 offset:53248
    v_mfma_f32_16x16x32_bf16 v[36:39], v[12:15], v[220:223], v[36:39]
    ds_read_b64_tr_b16 v[10:11], v5 offset:53760
    s_waitcnt lgkmcnt(4)
    v_mfma_f32_16x16x32_bf16 v[40:43], v[16:19], v[216:219], v[40:43]
    ds_read_b64_tr_b16 v[12:13], v5 offset:54272
    v_mfma_f32_16x16x32_bf16 v[44:47], v[16:19], v[220:223], v[44:47]
    ds_read_b64_tr_b16 v[14:15], v5 offset:54784
    s_waitcnt lgkmcnt(4)
    v_mfma_f32_16x16x32_bf16 v[48:51], v[20:23], v[216:219], v[48:51]
    s_barrier
    ds_read_b64_tr_b16 v[16:17], v5 offset:55296
    v_mfma_f32_16x16x32_bf16 v[52:55], v[20:23], v[220:223], v[52:55]
    ds_read_b64_tr_b16 v[18:19], v5 offset:55808
    s_add_u32 s74, s70, s88
    buffer_load_dwordx4 v[120:123], v7, s[36:39], s74 offen offset:0 sc1
    s_waitcnt lgkmcnt(4)
    v_mfma_f32_16x16x32_bf16 v[24:27], v[8:11], v[224:227], v[24:27]
    ds_read_b64_tr_b16 v[20:21], v5 offset:56320
    v_mfma_f32_16x16x32_bf16 v[28:31], v[8:11], v[228:231], v[28:31]
    ds_read_b64_tr_b16 v[22:23], v5 offset:56832
    s_waitcnt lgkmcnt(4)
    v_mfma_f32_16x16x32_bf16 v[32:35], v[12:15], v[224:227], v[32:35]
    ds_read_b64_tr_b16 v[8:9], v6 offset:0
    v_mfma_f32_16x16x32_bf16 v[36:39], v[12:15], v[228:231], v[36:39]
    ds_read_b64_tr_b16 v[10:11], v6 offset:512
    s_add_u32 s75, s71, s88
    buffer_load_dwordx4 v[124:127], v7, s[36:39], s75 offen offset:0 sc1
    s_waitcnt lgkmcnt(4)
    v_mfma_f32_16x16x32_bf16 v[40:43], v[16:19], v[224:227], v[40:43]
    ds_read_b64_tr_b16 v[12:13], v6 offset:1024
    v_mfma_f32_16x16x32_bf16 v[44:47], v[16:19], v[228:231], v[44:47]
    ds_read_b64_tr_b16 v[14:15], v6 offset:1536
    s_waitcnt lgkmcnt(4)
    v_mfma_f32_16x16x32_bf16 v[48:51], v[20:23], v[224:227], v[48:51]
    ds_read_b64_tr_b16 v[16:17], v6 offset:2048
    v_mfma_f32_16x16x32_bf16 v[52:55], v[20:23], v[228:231], v[52:55]
    ds_read_b64_tr_b16 v[18:19], v6 offset:2560
    s_waitcnt lgkmcnt(4)
    v_mfma_f32_16x16x32_bf16 v[24:27], v[8:11], v[232:235], v[24:27]
    ds_read_b64_tr_b16 v[20:21], v6 offset:3072
    v_mfma_f32_16x16x32_bf16 v[28:31], v[8:11], v[236:239], v[28:31]
    ds_read_b64_tr_b16 v[22:23], v6 offset:3584
    buffer_load_dwordx4 v[128:131], v7, s[36:39], s74 offen offset:2048 sc1
    s_waitcnt lgkmcnt(4)
    v_mfma_f32_16x16x32_bf16 v[32:35], v[12:15], v[232:235], v[32:35]
    ds_read_b64_tr_b16 v[8:9], v6 offset:4096
    v_mfma_f32_16x16x32_bf16 v[36:39], v[12:15], v[236:239], v[36:39]
    ds_read_b64_tr_b16 v[10:11], v6 offset:4608
    s_waitcnt lgkmcnt(4)
    v_mfma_f32_16x16x32_bf16 v[40:43], v[16:19], v[232:235], v[40:43]
    ds_read_b64_tr_b16 v[12:13], v6 offset:5120
    v_mfma_f32_16x16x32_bf16 v[44:47], v[16:19], v[236:239], v[44:47]
    ds_read_b64_tr_b16 v[14:15], v6 offset:5632
    buffer_load_dwordx4 v[132:135], v7, s[36:39], s75 offen offset:2048 sc1
    s_waitcnt lgkmcnt(4)
    v_mfma_f32_16x16x32_bf16 v[48:51], v[20:23], v[232:235], v[48:51]
    ds_read_b64_tr_b16 v[16:17], v6 offset:6144
    v_mfma_f32_16x16x32_bf16 v[52:55], v[20:23], v[236:239], v[52:55]
    ds_read_b64_tr_b16 v[18:19], v6 offset:6656
    s_waitcnt lgkmcnt(4)
    v_mfma_f32_16x16x32_bf16 v[24:27], v[8:11], v[240:243], v[24:27]
    ds_read_b64_tr_b16 v[20:21], v6 offset:7168
    v_mfma_f32_16x16x32_bf16 v[28:31], v[8:11], v[244:247], v[28:31]
    ds_read_b64_tr_b16 v[22:23], v6 offset:7680
    s_waitcnt lgkmcnt(4)
    v_mfma_f32_16x16x32_bf16 v[32:35], v[12:15], v[240:243], v[32:35]
    v_add_u32 v4, s73, v4
    v_add_u32 v5, s73, v5
    v_add_u32 v6, s73, v6
    s_barrier
    ds_read_b64_tr_b16 v[8:9], v4 offset:40960
    v_mfma_f32_16x16x32_bf16 v[36:39], v[12:15], v[244:247], v[36:39]
    ds_read_b64_tr_b16 v[10:11], v4 offset:41472
    s_add_u32 s74, s70, s89
    buffer_load_dwordx4 v[136:139], v7, s[36:39], s74 offen offset:0 sc1
    s_waitcnt lgkmcnt(4)
    v_mfma_f32_16x16x32_bf16 v[40:43], v[16:19], v[240:243], v[40:43]
    ds_read_b64_tr_b16 v[12:13], v4 offset:41984
    v_mfma_f32_16x16x32_bf16 v[44:47], v[16:19], v[244:247], v[44:47]
    ds_read_b64_tr_b16 v[14:15], v4 offset:42496
    s_waitcnt lgkmcnt(4)
    v_mfma_f32_16x16x32_bf16 v[48:51], v[20:23], v[240:243], v[48:51]
    ds_read_b64_tr_b16 v[16:17], v4 offset:43008
    v_mfma_f32_16x16x32_bf16 v[52:55], v[20:23], v[244:247], v[52:55]
    ds_read_b64_tr_b16 v[18:19], v4 offset:43520
    s_add_u32 s75, s71, s89
    buffer_load_dwordx4 v[140:143], v7, s[36:39], s75 offen offset:0 sc1
    s_waitcnt vmcnt(12)
    v_mul_f32 v24, v24, v32
    v_mul_f32 v25, v25, v33
    v_mul_f32 v26, v26, v34
    v_mul_f32 v27, v27, v35
    v_cvt_pk_bf16_f32 v248, v24, v25
    v_cvt_pk_bf16_f32 v249, v26, v27
    v_mul_f32 v40, v40, v48
    v_mul_f32 v41, v41, v49
    v_mul_f32 v42, v42, v50
    v_mul_f32 v43, v43, v51
    v_cvt_pk_bf16_f32 v250, v40, v41
    v_cvt_pk_bf16_f32 v251, v42, v43
    buffer_store_dwordx4 v[248:251], v7, s[36:39], s66 offen sc1
    s_add_u32 s66, s66, 16384
    v_mul_f32 v28, v28, v36
    v_mul_f32 v29, v29, v37
    v_mul_f32 v30, v30, v38
    v_mul_f32 v31, v31, v39
    v_cvt_pk_bf16_f32 v248, v28, v29
    v_cvt_pk_bf16_f32 v249, v30, v31
    v_mul_f32 v44, v44, v52
    v_mul_f32 v45, v45, v53
    v_mul_f32 v46, v46, v54
    v_mul_f32 v47, v47, v55
    v_cvt_pk_bf16_f32 v250, v44, v45
    v_cvt_pk_bf16_f32 v251, v46, v47
    buffer_store_dwordx4 v[248:251], v7, s[36:39], s67 offen sc1
    s_add_u32 s67, s67, 16384
    s_waitcnt lgkmcnt(4)
    v_mfma_f32_16x16x32_bf16 v[24:27], v[8:11], v[88:91], 0
    ds_read_b64_tr_b16 v[20:21], v4 offset:44032
    v_mfma_f32_16x16x32_bf16 v[44:47], v[8:11], v[92:95], 0
    ds_read_b64_tr_b16 v[22:23], v4 offset:44544
    s_waitcnt lgkmcnt(4)
    v_mfma_f32_16x16x32_bf16 v[28:31], v[12:15], v[88:91], 0
    ds_read_b64_tr_b16 v[8:9], v4 offset:45056
    v_mfma_f32_16x16x32_bf16 v[48:51], v[12:15], v[92:95], 0
    ds_read_b64_tr_b16 v[10:11], v4 offset:45568
    s_waitcnt lgkmcnt(4)
    v_mfma_f32_16x16x32_bf16 v[32:35], v[16:19], v[88:91], 0
    ds_read_b64_tr_b16 v[12:13], v4 offset:51200
    v_mfma_f32_16x16x32_bf16 v[52:55], v[16:19], v[92:95], 0
    ds_read_b64_tr_b16 v[14:15], v4 offset:51712
    buffer_load_dwordx4 v[144:147], v7, s[36:39], s74 offen offset:2048 sc1
    s_add_u32 s70, s70, 16384
    s_waitcnt lgkmcnt(4)
    v_mfma_f32_16x16x32_bf16 v[36:39], v[20:23], v[88:91], 0
    ds_read_b64_tr_b16 v[16:17], v4 offset:52224
    v_mfma_f32_16x16x32_bf16 v[56:59], v[20:23], v[92:95], 0
    ds_read_b64_tr_b16 v[18:19], v4 offset:52736
    buffer_load_dwordx4 v[148:151], v7, s[36:39], s75 offen offset:2048 sc1
    s_add_u32 s71, s71, 16384
    s_waitcnt lgkmcnt(4)
    v_mfma_f32_16x16x32_bf16 v[40:43], v[8:11], v[88:91], 0
    ds_read_b64_tr_b16 v[20:21], v4 offset:53248
    v_mfma_f32_16x16x32_bf16 v[60:63], v[8:11], v[92:95], 0
    ds_read_b64_tr_b16 v[22:23], v4 offset:53760
    s_waitcnt vmcnt(14)
    s_waitcnt lgkmcnt(4)
    v_mfma_f32_16x16x32_bf16 v[24:27], v[12:15], v[96:99], v[24:27]
    ds_read_b64_tr_b16 v[8:9], v4 offset:54272
    v_mfma_f32_16x16x32_bf16 v[44:47], v[12:15], v[100:103], v[44:47]
    ds_read_b64_tr_b16 v[10:11], v4 offset:54784
    s_waitcnt lgkmcnt(4)
    v_mfma_f32_16x16x32_bf16 v[28:31], v[16:19], v[96:99], v[28:31]
    ds_read_b64_tr_b16 v[12:13], v4 offset:55296
    v_mfma_f32_16x16x32_bf16 v[48:51], v[16:19], v[100:103], v[48:51]
    ds_read_b64_tr_b16 v[14:15], v4 offset:55808
    s_waitcnt lgkmcnt(4)
    v_mfma_f32_16x16x32_bf16 v[32:35], v[20:23], v[96:99], v[32:35]
    s_barrier
    ds_read_b64_tr_b16 v[16:17], v6 offset:8192
    v_mfma_f32_16x16x32_bf16 v[52:55], v[20:23], v[100:103], v[52:55]
    ds_read_b64_tr_b16 v[18:19], v6 offset:8704
    s_waitcnt lgkmcnt(4)
    v_mfma_f32_16x16x32_bf16 v[36:39], v[8:11], v[96:99], v[36:39]
    ds_read_b64_tr_b16 v[20:21], v6 offset:9216
    v_mfma_f32_16x16x32_bf16 v[56:59], v[8:11], v[100:103], v[56:59]
    ds_read_b64_tr_b16 v[22:23], v6 offset:9728
    s_waitcnt lgkmcnt(4)
    v_mfma_f32_16x16x32_bf16 v[40:43], v[12:15], v[96:99], v[40:43]
    ds_read_b64_tr_b16 v[8:9], v6 offset:10240
    v_mfma_f32_16x16x32_bf16 v[60:63], v[12:15], v[100:103], v[60:63]
    ds_read_b64_tr_b16 v[10:11], v6 offset:10752
    s_waitcnt vmcnt(12)
    s_waitcnt lgkmcnt(4)
    v_mfma_f32_16x16x32_bf16 v[24:27], v[16:19], v[104:107], v[24:27]
    ds_read_b64_tr_b16 v[12:13], v6 offset:11264
    v_mfma_f32_16x16x32_bf16 v[44:47], v[16:19], v[108:111], v[44:47]
    ds_read_b64_tr_b16 v[14:15], v6 offset:11776
    s_waitcnt lgkmcnt(4)
    v_mfma_f32_16x16x32_bf16 v[28:31], v[20:23], v[104:107], v[28:31]
    ds_read_b64_tr_b16 v[16:17], v6 offset:12288
    v_mfma_f32_16x16x32_bf16 v[48:51], v[20:23], v[108:111], v[48:51]
    ds_read_b64_tr_b16 v[18:19], v6 offset:12800
    s_waitcnt lgkmcnt(4)
    v_mfma_f32_16x16x32_bf16 v[32:35], v[8:11], v[104:107], v[32:35]
    ds_read_b64_tr_b16 v[20:21], v6 offset:18432
    v_mfma_f32_16x16x32_bf16 v[52:55], v[8:11], v[108:111], v[52:55]
    ds_read_b64_tr_b16 v[22:23], v6 offset:18944
    s_waitcnt lgkmcnt(4)
    v_mfma_f32_16x16x32_bf16 v[36:39], v[12:15], v[104:107], v[36:39]
    ds_read_b64_tr_b16 v[8:9], v6 offset:19456
    v_mfma_f32_16x16x32_bf16 v[56:59], v[12:15], v[108:111], v[56:59]
    ds_read_b64_tr_b16 v[10:11], v6 offset:19968
    s_waitcnt lgkmcnt(4)
    v_mfma_f32_16x16x32_bf16 v[40:43], v[16:19], v[104:107], v[40:43]
    ds_read_b64_tr_b16 v[12:13], v6 offset:20480
    v_mfma_f32_16x16x32_bf16 v[60:63], v[16:19], v[108:111], v[60:63]
    ds_read_b64_tr_b16 v[14:15], v6 offset:20992
    s_waitcnt vmcnt(10)
    s_waitcnt lgkmcnt(4)
    v_mfma_f32_16x16x32_bf16 v[24:27], v[20:23], v[112:115], v[24:27]
    ds_read_b64_tr_b16 v[16:17], v6 offset:21504
    v_mfma_f32_16x16x32_bf16 v[44:47], v[20:23], v[116:119], v[44:47]
    ds_read_b64_tr_b16 v[18:19], v6 offset:22016
    s_waitcnt lgkmcnt(4)
    v_mfma_f32_16x16x32_bf16 v[28:31], v[8:11], v[112:115], v[28:31]
    ds_read_b64_tr_b16 v[20:21], v6 offset:22528
    v_mfma_f32_16x16x32_bf16 v[48:51], v[8:11], v[116:119], v[48:51]
    ds_read_b64_tr_b16 v[22:23], v6 offset:23040
    s_waitcnt lgkmcnt(4)
    v_mfma_f32_16x16x32_bf16 v[32:35], v[12:15], v[112:115], v[32:35]
    s_waitcnt vmcnt(2)
    s_barrier
    ds_read_b64_tr_b16 v[8:9], v5 offset:24576
    v_mfma_f32_16x16x32_bf16 v[52:55], v[12:15], v[116:119], v[52:55]
    ds_read_b64_tr_b16 v[10:11], v5 offset:25088
    s_add_u32 s74, s70, s86
    buffer_load_dwordx4 v[152:155], v7, s[36:39], s74 offen offset:0 sc1
    s_waitcnt lgkmcnt(4)
    v_mfma_f32_16x16x32_bf16 v[36:39], v[16:19], v[112:115], v[36:39]
    ds_read_b64_tr_b16 v[12:13], v5 offset:25600
    v_mfma_f32_16x16x32_bf16 v[56:59], v[16:19], v[116:119], v[56:59]
    ds_read_b64_tr_b16 v[14:15], v5 offset:26112
    s_add_u32 s75, s71, s86
    buffer_load_dwordx4 v[156:159], v7, s[36:39], s75 offen offset:0 sc1
    s_waitcnt lgkmcnt(4)
    v_mfma_f32_16x16x32_bf16 v[40:43], v[20:23], v[112:115], v[40:43]
    ds_read_b64_tr_b16 v[16:17], v5 offset:26624
    v_mfma_f32_16x16x32_bf16 v[60:63], v[20:23], v[116:119], v[60:63]
    ds_read_b64_tr_b16 v[18:19], v5 offset:27136
    buffer_load_dwordx4 v[160:163], v7, s[36:39], s74 offen offset:2048 sc1
    s_waitcnt lgkmcnt(4)
    v_mfma_f32_16x16x32_bf16 v[24:27], v[8:11], v[120:123], v[24:27]
    ds_read_b64_tr_b16 v[20:21], v5 offset:27648
    v_mfma_f32_16x16x32_bf16 v[44:47], v[8:11], v[124:127], v[44:47]
    ds_read_b64_tr_b16 v[22:23], v5 offset:28160
    buffer_load_dwordx4 v[164:167], v7, s[36:39], s75 offen offset:2048 sc1
    s_waitcnt lgkmcnt(4)
    v_mfma_f32_16x16x32_bf16 v[28:31], v[12:15], v[120:123], v[28:31]
    ds_read_b64_tr_b16 v[8:9], v5 offset:28672
    v_mfma_f32_16x16x32_bf16 v[48:51], v[12:15], v[124:127], v[48:51]
    ds_read_b64_tr_b16 v[10:11], v5 offset:29184
    s_add_u32 s74, s70, s87
    buffer_load_dwordx4 v[168:171], v7, s[36:39], s74 offen offset:0 sc1
    s_waitcnt lgkmcnt(4)
    v_mfma_f32_16x16x32_bf16 v[32:35], v[16:19], v[120:123], v[32:35]
    ds_read_b64_tr_b16 v[12:13], v5 offset:34816
    v_mfma_f32_16x16x32_bf16 v[52:55], v[16:19], v[124:127], v[52:55]
    ds_read_b64_tr_b16 v[14:15], v5 offset:35328
    s_add_u32 s75, s71, s87
    buffer_load_dwordx4 v[172:175], v7, s[36:39], s75 offen offset:0 sc1
    s_waitcnt lgkmcnt(4)
    v_mfma_f32_16x16x32_bf16 v[36:39], v[20:23], v[120:123], v[36:39]
    ds_read_b64_tr_b16 v[16:17], v5 offset:35840
    v_mfma_f32_16x16x32_bf16 v[56:59], v[20:23], v[124:127], v[56:59]
    ds_read_b64_tr_b16 v[18:19], v5 offset:36352
    buffer_load_dwordx4 v[176:179], v7, s[36:39], s74 offen offset:2048 sc1
    s_waitcnt lgkmcnt(4)
    v_mfma_f32_16x16x32_bf16 v[40:43], v[8:11], v[120:123], v[40:43]
    ds_read_b64_tr_b16 v[20:21], v5 offset:36864
    v_mfma_f32_16x16x32_bf16 v[60:63], v[8:11], v[124:127], v[60:63]
    ds_read_b64_tr_b16 v[22:23], v5 offset:37376
    buffer_load_dwordx4 v[180:183], v7, s[36:39], s75 offen offset:2048 sc1
    s_waitcnt lgkmcnt(4)
    v_mfma_f32_16x16x32_bf16 v[24:27], v[12:15], v[128:131], v[24:27]
    ds_read_b64_tr_b16 v[8:9], v5 offset:37888
    v_mfma_f32_16x16x32_bf16 v[44:47], v[12:15], v[132:135], v[44:47]
    ds_read_b64_tr_b16 v[10:11], v5 offset:38400
    s_add_u32 s74, s70, s88
    buffer_load_dwordx4 v[184:187], v7, s[36:39], s74 offen offset:0 sc1
    s_waitcnt lgkmcnt(4)
    v_mfma_f32_16x16x32_bf16 v[28:31], v[16:19], v[128:131], v[28:31]
    ds_read_b64_tr_b16 v[12:13], v5 offset:38912
    v_mfma_f32_16x16x32_bf16 v[48:51], v[16:19], v[132:135], v[48:51]
    ds_read_b64_tr_b16 v[14:15], v5 offset:39424
    s_add_u32 s75, s71, s88
    buffer_load_dwordx4 v[188:191], v7, s[36:39], s75 offen offset:0 sc1
    s_waitcnt lgkmcnt(4)
    v_mfma_f32_16x16x32_bf16 v[32:35], v[20:23], v[128:131], v[32:35]
    s_barrier
    ds_read_b64_tr_b16 v[16:17], v4 offset:20480
    v_mfma_f32_16x16x32_bf16 v[52:55], v[20:23], v[132:135], v[52:55]
    ds_read_b64_tr_b16 v[18:19], v4 offset:20992
    buffer_load_dwordx4 v[192:195], v7, s[36:39], s74 offen offset:2048 sc1
    s_waitcnt lgkmcnt(4)
    v_mfma_f32_16x16x32_bf16 v[36:39], v[8:11], v[128:131], v[36:39]
    ds_read_b64_tr_b16 v[20:21], v4 offset:21504
    v_mfma_f32_16x16x32_bf16 v[56:59], v[8:11], v[132:135], v[56:59]
    ds_read_b64_tr_b16 v[22:23], v4 offset:22016
    buffer_load_dwordx4 v[196:199], v7, s[36:39], s75 offen offset:2048 sc1
    s_waitcnt lgkmcnt(4)
    v_mfma_f32_16x16x32_bf16 v[40:43], v[12:15], v[128:131], v[40:43]
    ds_read_b64_tr_b16 v[8:9], v4 offset:22528
    v_mfma_f32_16x16x32_bf16 v[60:63], v[12:15], v[132:135], v[60:63]
    ds_read_b64_tr_b16 v[10:11], v4 offset:23040
    s_add_u32 s74, s70, s89
    buffer_load_dwordx4 v[200:203], v7, s[36:39], s74 offen offset:0 sc1
    s_waitcnt lgkmcnt(4)
    v_mfma_f32_16x16x32_bf16 v[24:27], v[16:19], v[136:139], v[24:27]
    ds_read_b64_tr_b16 v[12:13], v4 offset:23552
    v_mfma_f32_16x16x32_bf16 v[44:47], v[16:19], v[140:143], v[44:47]
    ds_read_b64_tr_b16 v[14:15], v4 offset:24064
    s_add_u32 s75, s71, s89
    buffer_load_dwordx4 v[204:207], v7, s[36:39], s75 offen offset:0 sc1
    s_waitcnt lgkmcnt(4)
    v_mfma_f32_16x16x32_bf16 v[28:31], v[20:23], v[136:139], v[28:31]
    ds_read_b64_tr_b16 v[16:17], v4 offset:24576
    v_mfma_f32_16x16x32_bf16 v[48:51], v[20:23], v[140:143], v[48:51]
    ds_read_b64_tr_b16 v[18:19], v4 offset:25088
    buffer_load_dwordx4 v[208:211], v7, s[36:39], s74 offen offset:2048 sc1
    s_add_u32 s70, s70, 16384
    s_waitcnt lgkmcnt(4)
    v_mfma_f32_16x16x32_bf16 v[32:35], v[8:11], v[136:139], v[32:35]
    ds_read_b64_tr_b16 v[20:21], v4 offset:30720
    v_mfma_f32_16x16x32_bf16 v[52:55], v[8:11], v[140:143], v[52:55]
    ds_read_b64_tr_b16 v[22:23], v4 offset:31232
    buffer_load_dwordx4 v[212:215], v7, s[36:39], s75 offen offset:2048 sc1
    s_add_u32 s71, s71, 16384
    s_waitcnt lgkmcnt(4)
    v_mfma_f32_16x16x32_bf16 v[36:39], v[12:15], v[136:139], v[36:39]
    ds_read_b64_tr_b16 v[8:9], v4 offset:31744
    v_mfma_f32_16x16x32_bf16 v[56:59], v[12:15], v[140:143], v[56:59]
    ds_read_b64_tr_b16 v[10:11], v4 offset:32256
    s_waitcnt lgkmcnt(4)
    v_mfma_f32_16x16x32_bf16 v[40:43], v[16:19], v[136:139], v[40:43]
    ds_read_b64_tr_b16 v[12:13], v4 offset:32768
    v_mfma_f32_16x16x32_bf16 v[60:63], v[16:19], v[140:143], v[60:63]
    ds_read_b64_tr_b16 v[14:15], v4 offset:33280
    s_waitcnt vmcnt(16)
    s_waitcnt lgkmcnt(4)
    v_mfma_f32_16x16x32_bf16 v[24:27], v[20:23], v[144:147], v[24:27]
    ds_read_b64_tr_b16 v[16:17], v4 offset:33792
    v_mfma_f32_16x16x32_bf16 v[44:47], v[20:23], v[148:151], v[44:47]
    ds_read_b64_tr_b16 v[18:19], v4 offset:34304
    s_waitcnt lgkmcnt(4)
    v_mfma_f32_16x16x32_bf16 v[28:31], v[8:11], v[144:147], v[28:31]
    ds_read_b64_tr_b16 v[20:21], v4 offset:34816
    v_mfma_f32_16x16x32_bf16 v[48:51], v[8:11], v[148:151], v[48:51]
    ds_read_b64_tr_b16 v[22:23], v4 offset:35328
    s_waitcnt lgkmcnt(4)
    v_mfma_f32_16x16x32_bf16 v[32:35], v[12:15], v[144:147], v[32:35]
    s_barrier
    ds_read_b64_tr_b16 v[8:9], v6 offset:28672
    v_mfma_f32_16x16x32_bf16 v[52:55], v[12:15], v[148:151], v[52:55]
    ds_read_b64_tr_b16 v[10:11], v6 offset:29184
    s_waitcnt lgkmcnt(4)
    v_mfma_f32_16x16x32_bf16 v[36:39], v[16:19], v[144:147], v[36:39]
    ds_read_b64_tr_b16 v[12:13], v6 offset:29696
    v_mfma_f32_16x16x32_bf16 v[56:59], v[16:19], v[148:151], v[56:59]
    ds_read_b64_tr_b16 v[14:15], v6 offset:30208
    s_waitcnt lgkmcnt(4)
    v_mfma_f32_16x16x32_bf16 v[40:43], v[20:23], v[144:147], v[40:43]
    ds_read_b64_tr_b16 v[16:17], v6 offset:30720
    v_mfma_f32_16x16x32_bf16 v[60:63], v[20:23], v[148:151], v[60:63]
    ds_read_b64_tr_b16 v[18:19], v6 offset:31232
    s_waitcnt vmcnt(14)
    s_waitcnt lgkmcnt(4)
    v_mfma_f32_16x16x32_bf16 v[24:27], v[8:11], v[152:155], v[24:27]
    ds_read_b64_tr_b16 v[20:21], v6 offset:31744
    v_mfma_f32_16x16x32_bf16 v[44:47], v[8:11], v[156:159], v[44:47]
    ds_read_b64_tr_b16 v[22:23], v6 offset:32256
    s_waitcnt lgkmcnt(4)
    v_mfma_f32_16x16x32_bf16 v[28:31], v[12:15], v[152:155], v[28:31]
    ds_read_b64_tr_b16 v[8:9], v6 offset:32768
    v_mfma_f32_16x16x32_bf16 v[48:51], v[12:15], v[156:159], v[48:51]
    ds_read_b64_tr_b16 v[10:11], v6 offset:33280
    s_waitcnt lgkmcnt(4)
    v_mfma_f32_16x16x32_bf16 v[32:35], v[16:19], v[152:155], v[32:35]
    ds_read_b64_tr_b16 v[12:13], v6 offset:38912
    v_mfma_f32_16x16x32_bf16 v[52:55], v[16:19], v[156:159], v[52:55]
    ds_read_b64_tr_b16 v[14:15], v6 offset:39424
    s_waitcnt lgkmcnt(4)
    v_mfma_f32_16x16x32_bf16 v[36:39], v[20:23], v[152:155], v[36:39]
    ds_read_b64_tr_b16 v[16:17], v6 offset:39936
    v_mfma_f32_16x16x32_bf16 v[56:59], v[20:23], v[156:159], v[56:59]
    ds_read_b64_tr_b16 v[18:19], v6 offset:40448
    s_waitcnt lgkmcnt(4)
    v_mfma_f32_16x16x32_bf16 v[40:43], v[8:11], v[152:155], v[40:43]
    ds_read_b64_tr_b16 v[20:21], v6 offset:40960
    v_mfma_f32_16x16x32_bf16 v[60:63], v[8:11], v[156:159], v[60:63]
    ds_read_b64_tr_b16 v[22:23], v6 offset:41472
    s_waitcnt vmcnt(12)
    s_waitcnt lgkmcnt(4)
    v_mfma_f32_16x16x32_bf16 v[24:27], v[12:15], v[160:163], v[24:27]
    ds_read_b64_tr_b16 v[8:9], v6 offset:41984
    v_mfma_f32_16x16x32_bf16 v[44:47], v[12:15], v[164:167], v[44:47]
    ds_read_b64_tr_b16 v[10:11], v6 offset:42496
    s_waitcnt lgkmcnt(4)
    v_mfma_f32_16x16x32_bf16 v[28:31], v[16:19], v[160:163], v[28:31]
    ds_read_b64_tr_b16 v[12:13], v6 offset:43008
    v_mfma_f32_16x16x32_bf16 v[48:51], v[16:19], v[164:167], v[48:51]
    ds_read_b64_tr_b16 v[14:15], v6 offset:43520
    s_waitcnt lgkmcnt(4)
    v_mfma_f32_16x16x32_bf16 v[32:35], v[20:23], v[160:163], v[32:35]
    s_barrier
    ds_read_b64_tr_b16 v[16:17], v4 offset:0
    v_mfma_f32_16x16x32_bf16 v[52:55], v[20:23], v[164:167], v[52:55]
    ds_read_b64_tr_b16 v[18:19], v4 offset:512
    s_waitcnt lgkmcnt(4)
    v_mfma_f32_16x16x32_bf16 v[36:39], v[8:11], v[160:163], v[36:39]
    ds_read_b64_tr_b16 v[20:21], v4 offset:1024
    v_mfma_f32_16x16x32_bf16 v[56:59], v[8:11], v[164:167], v[56:59]
    ds_read_b64_tr_b16 v[22:23], v4 offset:1536
    s_waitcnt lgkmcnt(4)
    v_mfma_f32_16x16x32_bf16 v[40:43], v[12:15], v[160:163], v[40:43]
    ds_read_b64_tr_b16 v[8:9], v4 offset:2048
    v_mfma_f32_16x16x32_bf16 v[60:63], v[12:15], v[164:167], v[60:63]
    ds_read_b64_tr_b16 v[10:11], v4 offset:2560
    s_waitcnt vmcnt(10)
    s_waitcnt lgkmcnt(4)
    v_mfma_f32_16x16x32_bf16 v[24:27], v[16:19], v[168:171], v[24:27]
    ds_read_b64_tr_b16 v[12:13], v4 offset:3072
    v_mfma_f32_16x16x32_bf16 v[44:47], v[16:19], v[172:175], v[44:47]
    ds_read_b64_tr_b16 v[14:15], v4 offset:3584
    s_waitcnt lgkmcnt(4)
    v_mfma_f32_16x16x32_bf16 v[28:31], v[20:23], v[168:171], v[28:31]
    ds_read_b64_tr_b16 v[16:17], v4 offset:4096
    v_mfma_f32_16x16x32_bf16 v[48:51], v[20:23], v[172:175], v[48:51]
    ds_read_b64_tr_b16 v[18:19], v4 offset:4608
    s_waitcnt lgkmcnt(4)
    v_mfma_f32_16x16x32_bf16 v[32:35], v[8:11], v[168:171], v[32:35]
    ds_read_b64_tr_b16 v[20:21], v4 offset:10240
    v_mfma_f32_16x16x32_bf16 v[52:55], v[8:11], v[172:175], v[52:55]
    ds_read_b64_tr_b16 v[22:23], v4 offset:10752
    s_waitcnt lgkmcnt(4)
    v_mfma_f32_16x16x32_bf16 v[36:39], v[12:15], v[168:171], v[36:39]
    ds_read_b64_tr_b16 v[8:9], v4 offset:11264
    v_mfma_f32_16x16x32_bf16 v[56:59], v[12:15], v[172:175], v[56:59]
    ds_read_b64_tr_b16 v[10:11], v4 offset:11776
    s_waitcnt lgkmcnt(4)
    v_mfma_f32_16x16x32_bf16 v[40:43], v[16:19], v[168:171], v[40:43]
    ds_read_b64_tr_b16 v[12:13], v4 offset:12288
    v_mfma_f32_16x16x32_bf16 v[60:63], v[16:19], v[172:175], v[60:63]
    ds_read_b64_tr_b16 v[14:15], v4 offset:12800
    s_waitcnt vmcnt(8)
    s_waitcnt lgkmcnt(4)
    v_mfma_f32_16x16x32_bf16 v[24:27], v[20:23], v[176:179], v[24:27]
    ds_read_b64_tr_b16 v[16:17], v4 offset:13312
    v_mfma_f32_16x16x32_bf16 v[44:47], v[20:23], v[180:183], v[44:47]
    ds_read_b64_tr_b16 v[18:19], v4 offset:13824
    s_waitcnt lgkmcnt(4)
    v_mfma_f32_16x16x32_bf16 v[28:31], v[8:11], v[176:179], v[28:31]
    ds_read_b64_tr_b16 v[20:21], v4 offset:14336
    v_mfma_f32_16x16x32_bf16 v[48:51], v[8:11], v[180:183], v[48:51]
    ds_read_b64_tr_b16 v[22:23], v4 offset:14848
    s_waitcnt lgkmcnt(4)
    v_mfma_f32_16x16x32_bf16 v[32:35], v[12:15], v[176:179], v[32:35]
    s_barrier
    ds_read_b64_tr_b16 v[8:9], v5 offset:4096
    v_mfma_f32_16x16x32_bf16 v[52:55], v[12:15], v[180:183], v[52:55]
    ds_read_b64_tr_b16 v[10:11], v5 offset:4608
    s_waitcnt lgkmcnt(4)
    v_mfma_f32_16x16x32_bf16 v[36:39], v[16:19], v[176:179], v[36:39]
    ds_read_b64_tr_b16 v[12:13], v5 offset:5120
    v_mfma_f32_16x16x32_bf16 v[56:59], v[16:19], v[180:183], v[56:59]
    ds_read_b64_tr_b16 v[14:15], v5 offset:5632
    s_waitcnt lgkmcnt(4)
    v_mfma_f32_16x16x32_bf16 v[40:43], v[20:23], v[176:179], v[40:43]
    ds_read_b64_tr_b16 v[16:17], v5 offset:6144
    v_mfma_f32_16x16x32_bf16 v[60:63], v[20:23], v[180:183], v[60:63]
    ds_read_b64_tr_b16 v[18:19], v5 offset:6656
    s_waitcnt vmcnt(6)
    s_waitcnt lgkmcnt(4)
    v_mfma_f32_16x16x32_bf16 v[24:27], v[8:11], v[184:187], v[24:27]
    ds_read_b64_tr_b16 v[20:21], v5 offset:7168
    v_mfma_f32_16x16x32_bf16 v[44:47], v[8:11], v[188:191], v[44:47]
    ds_read_b64_tr_b16 v[22:23], v5 offset:7680
    s_waitcnt lgkmcnt(4)
    v_mfma_f32_16x16x32_bf16 v[28:31], v[12:15], v[184:187], v[28:31]
    ds_read_b64_tr_b16 v[8:9], v5 offset:8192
    v_mfma_f32_16x16x32_bf16 v[48:51], v[12:15], v[188:191], v[48:51]
    ds_read_b64_tr_b16 v[10:11], v5 offset:8704
    s_waitcnt lgkmcnt(4)
    v_mfma_f32_16x16x32_bf16 v[32:35], v[16:19], v[184:187], v[32:35]
    ds_read_b64_tr_b16 v[12:13], v5 offset:14336
    v_mfma_f32_16x16x32_bf16 v[52:55], v[16:19], v[188:191], v[52:55]
    ds_read_b64_tr_b16 v[14:15], v5 offset:14848
    s_waitcnt lgkmcnt(4)
    v_mfma_f32_16x16x32_bf16 v[36:39], v[20:23], v[184:187], v[36:39]
    ds_read_b64_tr_b16 v[16:17], v5 offset:15360
    v_mfma_f32_16x16x32_bf16 v[56:59], v[20:23], v[188:191], v[56:59]
    ds_read_b64_tr_b16 v[18:19], v5 offset:15872
    s_waitcnt lgkmcnt(4)
    v_mfma_f32_16x16x32_bf16 v[40:43], v[8:11], v[184:187], v[40:43]
    ds_read_b64_tr_b16 v[20:21], v5 offset:16384
    v_mfma_f32_16x16x32_bf16 v[60:63], v[8:11], v[188:191], v[60:63]
    ds_read_b64_tr_b16 v[22:23], v5 offset:16896
    s_waitcnt vmcnt(4)
    s_waitcnt lgkmcnt(4)
    v_mfma_f32_16x16x32_bf16 v[24:27], v[12:15], v[192:195], v[24:27]
    ds_read_b64_tr_b16 v[8:9], v5 offset:17408
    v_mfma_f32_16x16x32_bf16 v[44:47], v[12:15], v[196:199], v[44:47]
    ds_read_b64_tr_b16 v[10:11], v5 offset:17920
    s_waitcnt lgkmcnt(4)
    v_mfma_f32_16x16x32_bf16 v[28:31], v[16:19], v[192:195], v[28:31]
    ds_read_b64_tr_b16 v[12:13], v5 offset:18432
    v_mfma_f32_16x16x32_bf16 v[48:51], v[16:19], v[196:199], v[48:51]
    ds_read_b64_tr_b16 v[14:15], v5 offset:18944
    s_waitcnt lgkmcnt(4)
    v_mfma_f32_16x16x32_bf16 v[32:35], v[20:23], v[192:195], v[32:35]
    s_barrier
    ds_read_b64_tr_b16 v[16:17], v5 offset:45056
    v_mfma_f32_16x16x32_bf16 v[52:55], v[20:23], v[196:199], v[52:55]
    ds_read_b64_tr_b16 v[18:19], v5 offset:45568
    s_add_u32 s74, s70, s86
    buffer_load_dwordx4 v[216:219], v7, s[36:39], s74 offen offset:0 sc1
    s_waitcnt lgkmcnt(4)
    v_mfma_f32_16x16x32_bf16 v[36:39], v[8:11], v[192:195], v[36:39]
    ds_read_b64_tr_b16 v[20:21], v5 offset:46080
    v_mfma_f32_16x16x32_bf16 v[56:59], v[8:11], v[196:199], v[56:59]
    ds_read_b64_tr_b16 v[22:23], v5 offset:46592
    s_add_u32 s75, s71, s86
    buffer_load_dwordx4 v[220:223], v7, s[36:39], s75 offen offset:0 sc1
    s_waitcnt lgkmcnt(4)
    v_mfma_f32_16x16x32_bf16 v[40:43], v[12:15], v[192:195], v[40:43]
    ds_read_b64_tr_b16 v[8:9], v5 offset:47104
    v_mfma_f32_16x16x32_bf16 v[60:63], v[12:15], v[196:199], v[60:63]
    ds_read_b64_tr_b16 v[10:11], v5 offset:47616
    buffer_load_dwordx4 v[224:227], v7, s[36:39], s74 offen offset:2048 sc1
    s_waitcnt vmcnt(5)
    s_waitcnt lgkmcnt(4)
    v_mfma_f32_16x16x32_bf16 v[24:27], v[16:19], v[200:203], v[24:27]
    ds_read_b64_tr_b16 v[12:13], v5 offset:48128
    v_mfma_f32_16x16x32_bf16 v[44:47], v[16:19], v[204:207], v[44:47]
    ds_read_b64_tr_b16 v[14:15], v5 offset:48640
    buffer_load_dwordx4 v[228:231], v7, s[36:39], s75 offen offset:2048 sc1
    v_and_b32 v2, 15, v1
    v_lshlrev_b32 v2, 5, v2
    buffer_load_dwordx4 v[72:75], v2, s[36:39], s72 offen sc1
    buffer_load_dwordx4 v[76:79], v2, s[36:39], s72 offen offset:16 sc1
    s_waitcnt lgkmcnt(4)
    v_mfma_f32_16x16x32_bf16 v[28:31], v[20:23], v[200:203], v[28:31]
    ds_read_b64_tr_b16 v[16:17], v5 offset:49152
    v_mfma_f32_16x16x32_bf16 v[48:51], v[20:23], v[204:207], v[48:51]
    ds_read_b64_tr_b16 v[18:19], v5 offset:49664
    s_add_u32 s74, s70, s87
    buffer_load_dwordx4 v[232:235], v7, s[36:39], s74 offen offset:0 sc1
    s_waitcnt lgkmcnt(4)
    v_mfma_f32_16x16x32_bf16 v[32:35], v[8:11], v[200:203], v[32:35]
    ds_read_b64_tr_b16 v[20:21], v5 offset:55296
    v_mfma_f32_16x16x32_bf16 v[52:55], v[8:11], v[204:207], v[52:55]
    ds_read_b64_tr_b16 v[22:23], v5 offset:55808
    s_add_u32 s75, s71, s87
    buffer_load_dwordx4 v[236:239], v7, s[36:39], s75 offen offset:0 sc1
    s_waitcnt lgkmcnt(4)
    v_mfma_f32_16x16x32_bf16 v[36:39], v[12:15], v[200:203], v[36:39]
    ds_read_b64_tr_b16 v[8:9], v5 offset:56320
    v_mfma_f32_16x16x32_bf16 v[56:59], v[12:15], v[204:207], v[56:59]
    ds_read_b64_tr_b16 v[10:11], v5 offset:56832
    buffer_load_dwordx4 v[240:243], v7, s[36:39], s74 offen offset:2048 sc1
    s_waitcnt lgkmcnt(4)
    v_mfma_f32_16x16x32_bf16 v[40:43], v[16:19], v[200:203], v[40:43]
    ds_read_b64_tr_b16 v[12:13], v6 offset:0
    v_mfma_f32_16x16x32_bf16 v[60:63], v[16:19], v[204:207], v[60:63]
    ds_read_b64_tr_b16 v[14:15], v6 offset:512
    buffer_load_dwordx4 v[244:247], v7, s[36:39], s75 offen offset:2048 sc1
    s_waitcnt vmcnt(10)
    s_waitcnt lgkmcnt(4)
    v_mfma_f32_16x16x32_bf16 v[24:27], v[20:23], v[208:211], v[24:27]
    ds_read_b64_tr_b16 v[16:17], v6 offset:1024
    v_mfma_f32_16x16x32_bf16 v[44:47], v[20:23], v[212:215], v[44:47]
    ds_read_b64_tr_b16 v[18:19], v6 offset:1536
    s_add_u32 s74, s70, s88
    buffer_load_dwordx4 v[88:91], v7, s[36:39], s74 offen offset:0 sc1
    s_waitcnt lgkmcnt(4)
    v_mfma_f32_16x16x32_bf16 v[28:31], v[8:11], v[208:211], v[28:31]
    ds_read_b64_tr_b16 v[20:21], v6 offset:2048
    v_mfma_f32_16x16x32_bf16 v[48:51], v[8:11], v[212:215], v[48:51]
    ds_read_b64_tr_b16 v[22:23], v6 offset:2560
    s_add_u32 s75, s71, s88
    buffer_load_dwordx4 v[92:95], v7, s[36:39], s75 offen offset:0 sc1
    s_waitcnt lgkmcnt(4)
    v_mfma_f32_16x16x32_bf16 v[32:35], v[12:15], v[208:211], v[32:35]
    s_barrier
    ds_read_b64_tr_b16 v[8:9], v4 offset:40960
    v_mfma_f32_16x16x32_bf16 v[52:55], v[12:15], v[212:215], v[52:55]
    ds_read_b64_tr_b16 v[10:11], v4 offset:41472
    buffer_load_dwordx4 v[96:99], v7, s[36:39], s74 offen offset:2048 sc1
    s_waitcnt lgkmcnt(4)
    v_mfma_f32_16x16x32_bf16 v[36:39], v[16:19], v[208:211], v[36:39]
    ds_read_b64_tr_b16 v[12:13], v4 offset:41984
    v_mfma_f32_16x16x32_bf16 v[56:59], v[16:19], v[212:215], v[56:59]
    ds_read_b64_tr_b16 v[14:15], v4 offset:42496
    buffer_load_dwordx4 v[100:103], v7, s[36:39], s75 offen offset:2048 sc1
    s_waitcnt lgkmcnt(4)
    v_mfma_f32_16x16x32_bf16 v[40:43], v[20:23], v[208:211], v[40:43]
    ds_read_b64_tr_b16 v[16:17], v4 offset:43008
    v_mfma_f32_16x16x32_bf16 v[60:63], v[20:23], v[212:215], v[60:63]
    ds_read_b64_tr_b16 v[18:19], v4 offset:43520
    s_add_u32 s74, s70, s89
    buffer_load_dwordx4 v[104:107], v7, s[36:39], s74 offen offset:0 sc1
    s_waitcnt vmcnt(13)
    s_waitcnt lgkmcnt(4)
    v_mfma_f32_16x16x32_bf16 v[24:27], v[8:11], v[216:219], v[24:27]
    ds_read_b64_tr_b16 v[20:21], v4 offset:44032
    v_mfma_f32_16x16x32_bf16 v[44:47], v[8:11], v[220:223], v[44:47]
    ds_read_b64_tr_b16 v[22:23], v4 offset:44544
    s_add_u32 s75, s71, s89
    buffer_load_dwordx4 v[108:111], v7, s[36:39], s75 offen offset:0 sc1
    s_waitcnt lgkmcnt(4)
    v_mfma_f32_16x16x32_bf16 v[28:31], v[12:15], v[216:219], v[28:31]
    ds_read_b64_tr_b16 v[8:9], v4 offset:45056
    v_mfma_f32_16x16x32_bf16 v[48:51], v[12:15], v[220:223], v[48:51]
    ds_read_b64_tr_b16 v[10:11], v4 offset:45568
    buffer_load_dwordx4 v[112:115], v7, s[36:39], s74 offen offset:2048 sc1
    s_add_u32 s70, s70, 16384
    s_waitcnt lgkmcnt(4)
    v_mfma_f32_16x16x32_bf16 v[32:35], v[16:19], v[216:219], v[32:35]
    ds_read_b64_tr_b16 v[12:13], v4 offset:51200
    v_mfma_f32_16x16x32_bf16 v[52:55], v[16:19], v[220:223], v[52:55]
    ds_read_b64_tr_b16 v[14:15], v4 offset:51712
    buffer_load_dwordx4 v[116:119], v7, s[36:39], s75 offen offset:2048 sc1
    s_add_u32 s71, s71, 16384
    s_waitcnt lgkmcnt(4)
    v_mfma_f32_16x16x32_bf16 v[36:39], v[20:23], v[216:219], v[36:39]
    ds_read_b64_tr_b16 v[16:17], v4 offset:52224
    v_mfma_f32_16x16x32_bf16 v[56:59], v[20:23], v[220:223], v[56:59]
    ds_read_b64_tr_b16 v[18:19], v4 offset:52736
    s_waitcnt lgkmcnt(4)
    v_mfma_f32_16x16x32_bf16 v[40:43], v[8:11], v[216:219], v[40:43]
    ds_read_b64_tr_b16 v[20:21], v4 offset:53248
    v_mfma_f32_16x16x32_bf16 v[60:63], v[8:11], v[220:223], v[60:63]
    ds_read_b64_tr_b16 v[22:23], v4 offset:53760
    s_waitcnt vmcnt(14)
    s_waitcnt lgkmcnt(4)
    v_mfma_f32_16x16x32_bf16 v[24:27], v[12:15], v[224:227], v[24:27]
    ds_read_b64_tr_b16 v[8:9], v4 offset:54272
    v_mfma_f32_16x16x32_bf16 v[44:47], v[12:15], v[228:231], v[44:47]
    ds_read_b64_tr_b16 v[10:11], v4 offset:54784
    s_waitcnt lgkmcnt(4)
    v_mfma_f32_16x16x32_bf16 v[28:31], v[16:19], v[224:227], v[28:31]
    ds_read_b64_tr_b16 v[12:13], v4 offset:55296
    v_mfma_f32_16x16x32_bf16 v[48:51], v[16:19], v[228:231], v[48:51]
    ds_read_b64_tr_b16 v[14:15], v4 offset:55808
    s_waitcnt lgkmcnt(4)
    v_mfma_f32_16x16x32_bf16 v[32:35], v[20:23], v[224:227], v[32:35]
    s_barrier
    ds_read_b64_tr_b16 v[16:17], v6 offset:8192
    v_mfma_f32_16x16x32_bf16 v[52:55], v[20:23], v[228:231], v[52:55]
    ds_read_b64_tr_b16 v[18:19], v6 offset:8704
    s_waitcnt lgkmcnt(4)
    v_mfma_f32_16x16x32_bf16 v[36:39], v[8:11], v[224:227], v[36:39]
    ds_read_b64_tr_b16 v[20:21], v6 offset:9216
    v_mfma_f32_16x16x32_bf16 v[56:59], v[8:11], v[228:231], v[56:59]
    ds_read_b64_tr_b16 v[22:23], v6 offset:9728
    s_waitcnt lgkmcnt(4)
    v_mfma_f32_16x16x32_bf16 v[40:43], v[12:15], v[224:227], v[40:43]
    ds_read_b64_tr_b16 v[8:9], v6 offset:10240
    v_mfma_f32_16x16x32_bf16 v[60:63], v[12:15], v[228:231], v[60:63]
    ds_read_b64_tr_b16 v[10:11], v6 offset:10752
    s_waitcnt vmcnt(10)
    s_waitcnt lgkmcnt(4)
    v_mfma_f32_16x16x32_bf16 v[24:27], v[16:19], v[232:235], v[24:27]
    ds_read_b64_tr_b16 v[12:13], v6 offset:11264
    v_mfma_f32_16x16x32_bf16 v[44:47], v[16:19], v[236:239], v[44:47]
    ds_read_b64_tr_b16 v[14:15], v6 offset:11776
    s_waitcnt lgkmcnt(4)
    v_mfma_f32_16x16x32_bf16 v[28:31], v[20:23], v[232:235], v[28:31]
    ds_read_b64_tr_b16 v[16:17], v6 offset:12288
    v_mfma_f32_16x16x32_bf16 v[48:51], v[20:23], v[236:239], v[48:51]
    ds_read_b64_tr_b16 v[18:19], v6 offset:12800
    s_waitcnt lgkmcnt(4)
    v_mfma_f32_16x16x32_bf16 v[32:35], v[8:11], v[232:235], v[32:35]
    ds_read_b64_tr_b16 v[20:21], v6 offset:18432
    v_mfma_f32_16x16x32_bf16 v[52:55], v[8:11], v[236:239], v[52:55]
    ds_read_b64_tr_b16 v[22:23], v6 offset:18944
    s_waitcnt lgkmcnt(4)
    v_mfma_f32_16x16x32_bf16 v[36:39], v[12:15], v[232:235], v[36:39]
    ds_read_b64_tr_b16 v[8:9], v6 offset:19456
    v_mfma_f32_16x16x32_bf16 v[56:59], v[12:15], v[236:239], v[56:59]
    ds_read_b64_tr_b16 v[10:11], v6 offset:19968
    s_waitcnt lgkmcnt(4)
    v_mfma_f32_16x16x32_bf16 v[40:43], v[16:19], v[232:235], v[40:43]
    ds_read_b64_tr_b16 v[12:13], v6 offset:20480
    v_mfma_f32_16x16x32_bf16 v[60:63], v[16:19], v[236:239], v[60:63]
    ds_read_b64_tr_b16 v[14:15], v6 offset:20992
    s_waitcnt vmcnt(8)
    s_waitcnt lgkmcnt(4)
    v_mfma_f32_16x16x32_bf16 v[24:27], v[20:23], v[240:243], v[24:27]
    ds_read_b64_tr_b16 v[16:17], v6 offset:21504
    v_mfma_f32_16x16x32_bf16 v[44:47], v[20:23], v[244:247], v[44:47]
    ds_read_b64_tr_b16 v[18:19], v6 offset:22016
    s_waitcnt lgkmcnt(4)
    v_mfma_f32_16x16x32_bf16 v[28:31], v[8:11], v[240:243], v[28:31]
    ds_read_b64_tr_b16 v[20:21], v6 offset:22528
    v_mfma_f32_16x16x32_bf16 v[48:51], v[8:11], v[244:247], v[48:51]
    ds_read_b64_tr_b16 v[22:23], v6 offset:23040
    s_waitcnt lgkmcnt(4)
    v_mfma_f32_16x16x32_bf16 v[32:35], v[12:15], v[240:243], v[32:35]
    s_barrier
    ds_read_b64_tr_b16 v[8:9], v5 offset:24576
    v_mfma_f32_16x16x32_bf16 v[52:55], v[12:15], v[244:247], v[52:55]
    ds_read_b64_tr_b16 v[10:11], v5 offset:25088
    s_waitcnt lgkmcnt(4)
    v_mfma_f32_16x16x32_bf16 v[36:39], v[16:19], v[240:243], v[36:39]
    ds_read_b64_tr_b16 v[12:13], v5 offset:25600
    v_mfma_f32_16x16x32_bf16 v[56:59], v[16:19], v[244:247], v[56:59]
    ds_read_b64_tr_b16 v[14:15], v5 offset:26112
    s_waitcnt lgkmcnt(4)
    v_mfma_f32_16x16x32_bf16 v[40:43], v[20:23], v[240:243], v[40:43]
    ds_read_b64_tr_b16 v[16:17], v5 offset:26624
    v_mfma_f32_16x16x32_bf16 v[60:63], v[20:23], v[244:247], v[60:63]
    ds_read_b64_tr_b16 v[18:19], v5 offset:27136
    s_waitcnt vmcnt(6)
    s_waitcnt lgkmcnt(4)
    v_mfma_f32_16x16x32_bf16 v[24:27], v[8:11], v[88:91], v[24:27]
    ds_read_b64_tr_b16 v[20:21], v5 offset:27648
    v_mfma_f32_16x16x32_bf16 v[44:47], v[8:11], v[92:95], v[44:47]
    ds_read_b64_tr_b16 v[22:23], v5 offset:28160
    s_waitcnt lgkmcnt(4)
    v_mfma_f32_16x16x32_bf16 v[28:31], v[12:15], v[88:91], v[28:31]
    ds_read_b64_tr_b16 v[8:9], v5 offset:28672
    v_mfma_f32_16x16x32_bf16 v[48:51], v[12:15], v[92:95], v[48:51]
    ds_read_b64_tr_b16 v[10:11], v5 offset:29184
    s_waitcnt lgkmcnt(4)
    v_mfma_f32_16x16x32_bf16 v[32:35], v[16:19], v[88:91], v[32:35]
    ds_read_b64_tr_b16 v[12:13], v5 offset:34816
    v_mfma_f32_16x16x32_bf16 v[52:55], v[16:19], v[92:95], v[52:55]
    ds_read_b64_tr_b16 v[14:15], v5 offset:35328
    s_waitcnt lgkmcnt(4)
    v_mfma_f32_16x16x32_bf16 v[36:39], v[20:23], v[88:91], v[36:39]
    ds_read_b64_tr_b16 v[16:17], v5 offset:35840
    v_mfma_f32_16x16x32_bf16 v[56:59], v[20:23], v[92:95], v[56:59]
    ds_read_b64_tr_b16 v[18:19], v5 offset:36352
    s_waitcnt lgkmcnt(4)
    v_mfma_f32_16x16x32_bf16 v[40:43], v[8:11], v[88:91], v[40:43]
    ds_read_b64_tr_b16 v[20:21], v5 offset:36864
    v_mfma_f32_16x16x32_bf16 v[60:63], v[8:11], v[92:95], v[60:63]
    ds_read_b64_tr_b16 v[22:23], v5 offset:37376
    s_waitcnt vmcnt(4)
    s_waitcnt lgkmcnt(4)
    v_mfma_f32_16x16x32_bf16 v[24:27], v[12:15], v[96:99], v[24:27]
    ds_read_b64_tr_b16 v[8:9], v5 offset:37888
    v_mfma_f32_16x16x32_bf16 v[44:47], v[12:15], v[100:103], v[44:47]
    ds_read_b64_tr_b16 v[10:11], v5 offset:38400
    s_waitcnt lgkmcnt(4)
    v_mfma_f32_16x16x32_bf16 v[28:31], v[16:19], v[96:99], v[28:31]
    ds_read_b64_tr_b16 v[12:13], v5 offset:38912
    v_mfma_f32_16x16x32_bf16 v[48:51], v[16:19], v[100:103], v[48:51]
    ds_read_b64_tr_b16 v[14:15], v5 offset:39424
    s_waitcnt lgkmcnt(4)
    v_mfma_f32_16x16x32_bf16 v[32:35], v[20:23], v[96:99], v[32:35]
    s_barrier
    ds_read_b64_tr_b16 v[16:17], v4 offset:20480
    v_mfma_f32_16x16x32_bf16 v[52:55], v[20:23], v[100:103], v[52:55]
    ds_read_b64_tr_b16 v[18:19], v4 offset:20992
    s_waitcnt lgkmcnt(4)
    v_mfma_f32_16x16x32_bf16 v[36:39], v[8:11], v[96:99], v[36:39]
    ds_read_b64_tr_b16 v[20:21], v4 offset:21504
    v_mfma_f32_16x16x32_bf16 v[56:59], v[8:11], v[100:103], v[56:59]
    ds_read_b64_tr_b16 v[22:23], v4 offset:22016
    s_waitcnt lgkmcnt(4)
    v_mfma_f32_16x16x32_bf16 v[40:43], v[12:15], v[96:99], v[40:43]
    ds_read_b64_tr_b16 v[8:9], v4 offset:22528
    v_mfma_f32_16x16x32_bf16 v[60:63], v[12:15], v[100:103], v[60:63]
    ds_read_b64_tr_b16 v[10:11], v4 offset:23040
    s_waitcnt vmcnt(2)
    s_waitcnt lgkmcnt(4)
    v_mfma_f32_16x16x32_bf16 v[24:27], v[16:19], v[104:107], v[24:27]
    ds_read_b64_tr_b16 v[12:13], v4 offset:23552
    v_mfma_f32_16x16x32_bf16 v[44:47], v[16:19], v[108:111], v[44:47]
    ds_read_b64_tr_b16 v[14:15], v4 offset:24064
    s_waitcnt lgkmcnt(4)
    v_mfma_f32_16x16x32_bf16 v[28:31], v[20:23], v[104:107], v[28:31]
    ds_read_b64_tr_b16 v[16:17], v4 offset:24576
    v_mfma_f32_16x16x32_bf16 v[48:51], v[20:23], v[108:111], v[48:51]
    ds_read_b64_tr_b16 v[18:19], v4 offset:25088
    s_waitcnt lgkmcnt(4)
    v_mfma_f32_16x16x32_bf16 v[32:35], v[8:11], v[104:107], v[32:35]
    ds_read_b64_tr_b16 v[20:21], v4 offset:30720
    v_mfma_f32_16x16x32_bf16 v[52:55], v[8:11], v[108:111], v[52:55]
    ds_read_b64_tr_b16 v[22:23], v4 offset:31232
    s_waitcnt lgkmcnt(4)
    v_mfma_f32_16x16x32_bf16 v[36:39], v[12:15], v[104:107], v[36:39]
    ds_read_b64_tr_b16 v[8:9], v4 offset:31744
    v_mfma_f32_16x16x32_bf16 v[56:59], v[12:15], v[108:111], v[56:59]
    ds_read_b64_tr_b16 v[10:11], v4 offset:32256
    s_waitcnt lgkmcnt(4)
    v_mfma_f32_16x16x32_bf16 v[40:43], v[16:19], v[104:107], v[40:43]
    ds_read_b64_tr_b16 v[12:13], v4 offset:32768
    v_mfma_f32_16x16x32_bf16 v[60:63], v[16:19], v[108:111], v[60:63]
    ds_read_b64_tr_b16 v[14:15], v4 offset:33280
    s_waitcnt vmcnt(0)
    s_waitcnt lgkmcnt(4)
    v_mfma_f32_16x16x32_bf16 v[24:27], v[20:23], v[112:115], v[24:27]
    ds_read_b64_tr_b16 v[16:17], v4 offset:33792
    v_mfma_f32_16x16x32_bf16 v[44:47], v[20:23], v[116:119], v[44:47]
    ds_read_b64_tr_b16 v[18:19], v4 offset:34304
    s_waitcnt lgkmcnt(4)
    v_mfma_f32_16x16x32_bf16 v[28:31], v[8:11], v[112:115], v[28:31]
    ds_read_b64_tr_b16 v[20:21], v4 offset:34816
    v_mfma_f32_16x16x32_bf16 v[48:51], v[8:11], v[116:119], v[48:51]
    ds_read_b64_tr_b16 v[22:23], v4 offset:35328
    s_waitcnt lgkmcnt(4)
    v_mfma_f32_16x16x32_bf16 v[32:35], v[12:15], v[112:115], v[32:35]
    v_mfma_f32_16x16x32_bf16 v[52:55], v[12:15], v[116:119], v[52:55]
    s_waitcnt lgkmcnt(2)
    v_mfma_f32_16x16x32_bf16 v[36:39], v[16:19], v[112:115], v[36:39]
    v_mfma_f32_16x16x32_bf16 v[56:59], v[16:19], v[116:119], v[56:59]
    s_waitcnt lgkmcnt(0)
    v_mfma_f32_16x16x32_bf16 v[40:43], v[20:23], v[112:115], v[40:43]
    v_mfma_f32_16x16x32_bf16 v[60:63], v[20:23], v[116:119], v[60:63]
    v_lshlrev_b32 v18, 3, v1
    s_add_u32 s3, s82, 98304
    v_add_u32 v18, s3, v18
    ds_read_b64 v[240:241], v18 offset:0
    ds_read_b64 v[242:243], v18 offset:512
    ds_read_b64 v[244:245], v18 offset:1024
    ds_read_b64 v[246:247], v18 offset:1536
    ds_read_b64 v[248:249], v18 offset:2048
    s_add_u32 s3, s80, 0
    v_add_u32 v16, s3, v7
    s_xor_b32 s3, s44, 1
    s_mul_i32 s3, s3, 5120
    s_add_u32 s3, s3, 0
    v_add_u32 v17, s3, v7
    ds_write_b128 v16, v[44:47] offset:0
    ds_write_b128 v16, v[48:51] offset:1024
    ds_write_b128 v16, v[52:55] offset:2048
    ds_write_b128 v16, v[56:59] offset:3072
    ds_write_b128 v16, v[60:63] offset:4096
    v_add_f32 v72, v72, v73
    v_add_f32 v72, v72, v74
    v_add_f32 v72, v72, v75
    v_add_f32 v72, v72, v76
    v_add_f32 v72, v72, v77
    v_add_f32 v72, v72, v78
    v_add_f32 v72, v72, v79
    v_mov_b32 v18, 0x3727c5ac
    v_fmac_f32 v18, 0x3acccccd, v72
    v_rcp_f32 v18, v18
    v_lshrrev_b32 v2, 4, v1
    v_and_b32 v14, 15, v1
    v_mul_u32_u24 v15, 1280, v14
    v_lshl_add_u32 v15, v2, 3, v15
    s_waitcnt lgkmcnt(0)
    s_barrier
    ds_read_b128 v[88:91], v17 offset:0
    ds_read_b128 v[92:95], v17 offset:1024
    ds_read_b128 v[96:99], v17 offset:2048
    ds_read_b128 v[100:103], v17 offset:3072
    ds_read_b128 v[104:107], v17 offset:4096
    s_waitcnt lgkmcnt(4)
    v_add_f32 v24, v24, v88
    v_add_f32 v25, v25, v89
    v_add_f32 v26, v26, v90
    v_add_f32 v27, v27, v91
    v_lshlrev_b32 v2, 16, v240
    v_and_b32 v3, 0xffff0000, v240
    v_fmac_f32 v2, v18, v24
    v_fmac_f32 v3, v18, v25
    v_cvt_pk_bf16_f32 v8, v2, v3
    v_lshlrev_b32 v2, 16, v241
    v_and_b32 v3, 0xffff0000, v241
    v_fmac_f32 v2, v18, v26
    v_fmac_f32 v3, v18, v27
    v_cvt_pk_bf16_f32 v9, v2, v3
    buffer_store_dwordx2 v[8:9], v15, s[32:35], s60 offen offset:0
    s_waitcnt lgkmcnt(3)
    v_add_f32 v28, v28, v92
    v_add_f32 v29, v29, v93
    v_add_f32 v30, v30, v94
    v_add_f32 v31, v31, v95
    v_lshlrev_b32 v2, 16, v242
    v_and_b32 v3, 0xffff0000, v242
    v_fmac_f32 v2, v18, v28
    v_fmac_f32 v3, v18, v29
    v_cvt_pk_bf16_f32 v10, v2, v3
    v_lshlrev_b32 v2, 16, v243
    v_and_b32 v3, 0xffff0000, v243
    v_fmac_f32 v2, v18, v30
    v_fmac_f32 v3, v18, v31
    v_cvt_pk_bf16_f32 v11, v2, v3
    buffer_store_dwordx2 v[10:11], v15, s[32:35], s60 offen offset:32
    s_waitcnt lgkmcnt(2)
    v_add_f32 v32, v32, v96
    v_add_f32 v33, v33, v97
    v_add_f32 v34, v34, v98
    v_add_f32 v35, v35, v99
    v_lshlrev_b32 v2, 16, v244
    v_and_b32 v3, 0xffff0000, v244
    v_fmac_f32 v2, v18, v32
    v_fmac_f32 v3, v18, v33
    v_cvt_pk_bf16_f32 v8, v2, v3
    v_lshlrev_b32 v2, 16, v245
    v_and_b32 v3, 0xffff0000, v245
    v_fmac_f32 v2, v18, v34
    v_fmac_f32 v3, v18, v35
    v_cvt_pk_bf16_f32 v9, v2, v3
    buffer_store_dwordx2 v[8:9], v15, s[32:35], s60 offen offset:64
    s_waitcnt lgkmcnt(1)
    v_add_f32 v36, v36, v100
    v_add_f32 v37, v37, v101
    v_add_f32 v38, v38, v102
    v_add_f32 v39, v39, v103
    v_lshlrev_b32 v2, 16, v246
    v_and_b32 v3, 0xffff0000, v246
    v_fmac_f32 v2, v18, v36
    v_fmac_f32 v3, v18, v37
    v_cvt_pk_bf16_f32 v10, v2, v3
    v_lshlrev_b32 v2, 16, v247
    v_and_b32 v3, 0xffff0000, v247
    v_fmac_f32 v2, v18, v38
    v_fmac_f32 v3, v18, v39
    v_cvt_pk_bf16_f32 v11, v2, v3
    buffer_store_dwordx2 v[10:11], v15, s[32:35], s60 offen offset:96
    s_waitcnt lgkmcnt(0)
    v_add_f32 v40, v40, v104
    v_add_f32 v41, v41, v105
    v_add_f32 v42, v42, v106
    v_add_f32 v43, v43, v107
    v_lshlrev_b32 v2, 16, v248
    v_and_b32 v3, 0xffff0000, v248
    v_fmac_f32 v2, v18, v40
    v_fmac_f32 v3, v18, v41
    v_cvt_pk_bf16_f32 v8, v2, v3
    v_lshlrev_b32 v2, 16, v249
    v_and_b32 v3, 0xffff0000, v249
    v_fmac_f32 v2, v18, v42
    v_fmac_f32 v3, v18, v43
    v_cvt_pk_bf16_f32 v9, v2, v3
    buffer_store_dwordx2 v[8:9], v15, s[32:35], s60 offen offset:128
    s_branch L_fin
L_helper:
    s_lshl_b32 s76, s2, 7
    s_cmp_eq_u32 s44, 7
    s_cselect_b32 s76, s76, 1073741824
    s_add_u32 s88, s76, 32768
    s_mov_b32 s87, 32768
    s_and_b32 s57, s44, 3
    s_mul_i32 s80, s57, 5120
    s_mul_i32 s78, s95, 245760
    s_add_u32 s78, s78, s80
    s_add_u32 s78, s78, 25165824
    s_mul_i32 s81, s53, 245760
    s_add_u32 s81, s81, s80
    s_add_u32 s81, s81, 29360128
    v_lshlrev_b32 v7, 4, v1
    s_lshl_b32 s59, s52, 2
    s_add_u32 s59, s59, s57
    s_and_b32 s58, s57, 1
    s_lshl_b32 s62, s59, 14
    s_lshl_b32 s4, s58, 13
    s_add_u32 s62, s62, s4
    s_add_u32 s62, s62, 9442304
    s_xor_b32 s63, s62, 16384
    s_lshl_b32 s66, s59, 12
    s_lshl_b32 s5, s58, 11
    s_add_u32 s66, s66, s5
    s_add_u32 s66, s66, 11534336
    s_xor_b32 s67, s66, 4096
    s_mul_i32 s64, s57, 10240
    v_and_b32 v16, 15, v1
    v_lshlrev_b32 v16, 2, v16
    s_lshl_b32 s3, s2, 7
    v_add_u32 v16, s3, v16
    v_bfe_u32 v17, v1, 4, 1
    v_lshl_add_u32 v16, v17, 15, v16
    v_mov_b32 v17, 0
    v_writelane_b32 v17, 32, 5
    v_writelane_b32 v17, 16, 19
    s_cmp_eq_u32 s44, 7
    s_cbranch_scc0 L_h_np0
    s_mov_b32 s3, 0
Lpoll_17:
    buffer_load_dword v18, v16, s[36:39], 0 offen sc1
    s_add_u32 s3, s3, 1
    s_waitcnt vmcnt(0)
    v_cmp_lt_u32 vcc, v18, v17
    s_cmp_gt_u32 s3, 262144
    s_cbranch_scc1 Lpollx_18
    s_cbranch_vccnz Lpoll_17
Lpollx_18:
L_h_np0:
    s_waitcnt vmcnt(0)
    v_mov_b32 v22, 1
    s_barrier
    s_cmp_eq_u32 s44, 5
    s_cbranch_scc0 L_h_w5
    s_mov_b32 exec_hi, 0
    buffer_atomic_add v22, v234, s[36:39], 0 offen sc1
    s_mov_b64 exec, -1
L_h_w5:
    s_lshl_b32 s5, s94, 1
    v_and_b32 v21, 3, v1
    v_lshlrev_b32 v21, 13, v21
    v_bfe_u32 v2, v1, 2, 1
    v_lshl_add_u32 v21, v2, 7, v21
    v_bfe_u32 v2, v1, 3, 1
    v_lshl_add_u32 v21, v2, 10, v21
    s_and_b32 s3, s5, 7
    s_lshl_b32 s3, s3, 10
    s_lshr_b32 s4, s5, 3
    s_lshl_b32 s4, s4, 8
    s_add_u32 s3, s3, s4
    s_add_u32 s3, s3, 24
    v_add_u32 v21, s3, v21
    v_mov_b32 v22, 1
    s_lshl_b32 s77, s57, 12
    s_lshl_b32 s61, s94, 3
    s_lshl_b32 s3, s57, 1
    s_add_u32 s61, s61, s3
    s_mul_i32 s68, s61, 20480
    s_add_u32 s68, s68, 12582912
    s_add_u32 s69, s68, 19456
    s_lshl_b32 s59, s52, 2
    s_add_u32 s59, s59, s57
    s_and_b32 s3, s57, 1
    s_lshl_b32 s3, s3, 10
    s_add_u32 s3, s3, 16777216
    s_mul_i32 s70, s59, 49152
    s_add_u32 s70, s70, s3
    s_xor_b32 s61, s59, 1
    s_mul_i32 s71, s61, 49152
    s_add_u32 s71, s71, s3
    s_sub_u32 s71, s71, 1024
    v_lshlrev_b32 v8, 3, v1
    s_mul_i32 s3, s57, 2560
    v_add_u32 v8, s3, v8
    v_add_u32 v9, 143360, v8
    s_waitcnt vmcnt(0)
    s_barrier
    s_mov_b32 s3, 0
    s_add_u32 s90, s81, s3
    s_mov_b32 s3, 20480
    s_add_u32 s91, s81, s3
    s_mov_b32 s3, 40960
    s_add_u32 s92, s81, s3
    s_mov_b32 s3, 61440
    s_add_u32 s93, s81, s3
    s_add_u32 m0, s80, 0
    s_add_u32 s79, s78, 0
    buffer_load_dwordx4 v7, s[36:39], s79 offen sc1 lds
    s_add_u32 m0, s80, 1024
    s_add_u32 s79, s78, 1024
    buffer_load_dwordx4 v7, s[36:39], s79 offen sc1 lds
    s_add_u32 m0, s80, 2048
    s_add_u32 s79, s78, 2048
    buffer_load_dwordx4 v7, s[36:39], s79 offen sc1 lds
    s_add_u32 m0, s80, 3072
    s_add_u32 s79, s78, 3072
    buffer_load_dwordx4 v7, s[36:39], s79 offen sc1 lds
    s_add_u32 m0, s80, 4096
    s_add_u32 s79, s78, 4096
    buffer_load_dwordx4 v7, s[36:39], s79 offen sc1 lds
    s_barrier
    s_add_u32 m0, s80, 61440
    s_add_u32 s79, s78, 20480
    buffer_load_dwordx4 v7, s[36:39], s79 offen sc1 lds
    s_add_u32 m0, s80, 62464
    s_add_u32 s79, s78, 21504
    buffer_load_dwordx4 v7, s[36:39], s79 offen sc1 lds
    s_add_u32 m0, s80, 63488
    s_add_u32 s79, s78, 22528
    buffer_load_dwordx4 v7, s[36:39], s79 offen sc1 lds
    s_add_u32 m0, s80, 64512
    s_add_u32 s79, s78, 23552
    buffer_load_dwordx4 v7, s[36:39], s79 offen sc1 lds
    s_add_u32 m0, s80, 65536
    s_add_u32 s79, s78, 24576
    buffer_load_dwordx4 v7, s[36:39], s79 offen sc1 lds
    s_barrier
    s_barrier
    s_cmp_eq_u32 s44, 4
    s_cbranch_scc0 Lhs_19
    s_mov_b64 exec, 0xffff
    buffer_atomic_add v22, v21, s[36:39], 0 offen offset:0 sc1
    s_mov_b64 exec, -1
Lhs_19:
    ds_read_b64 v[32:33], v8 offset:45056
    ds_read_b64 v[34:35], v8 offset:45568
    ds_read_b64 v[36:37], v8 offset:46080
    ds_read_b64 v[38:39], v8 offset:46592
    ds_read_b64 v[40:41], v8 offset:47104
    s_add_u32 m0, s80, 81920
    s_add_u32 s79, s78, 40960
    buffer_load_dwordx4 v7, s[36:39], s79 offen sc1 lds
    s_add_u32 m0, s80, 82944
    s_add_u32 s79, s78, 41984
    buffer_load_dwordx4 v7, s[36:39], s79 offen sc1 lds
    s_add_u32 m0, s80, 83968
    s_add_u32 s79, s78, 43008
    buffer_load_dwordx4 v7, s[36:39], s79 offen sc1 lds
    s_add_u32 m0, s80, 84992
    s_add_u32 s79, s78, 44032
    buffer_load_dwordx4 v7, s[36:39], s79 offen sc1 lds
    s_add_u32 m0, s80, 86016
    s_add_u32 s79, s78, 45056
    buffer_load_dwordx4 v7, s[36:39], s79 offen sc1 lds
    s_add_u32 m0, s80, 102400
    s_add_u32 s79, s78, 61440
    buffer_load_dwordx4 v7, s[36:39], s79 offen sc1 lds
    s_add_u32 m0, s80, 103424
    s_add_u32 s79, s78, 62464
    buffer_load_dwordx4 v7, s[36:39], s79 offen sc1 lds
    s_add_u32 m0, s80, 104448
    s_add_u32 s79, s78, 63488
    buffer_load_dwordx4 v7, s[36:39], s79 offen sc1 lds
    s_add_u32 m0, s80, 105472
    s_add_u32 s79, s78, 64512
    buffer_load_dwordx4 v7, s[36:39], s79 offen sc1 lds
    s_add_u32 m0, s80, 106496
    s_add_u32 s79, s78, 65536
    buffer_load_dwordx4 v7, s[36:39], s79 offen sc1 lds
    s_cmp_eq_u32 s44, 7
    s_cbranch_scc0 Lhp_20
    v_mov_b32 v17, 0
    v_writelane_b32 v17, 16, 6
    v_writelane_b32 v17, 32, 20
    s_mov_b32 s3, 0
Lpoll_21:
    buffer_load_dword v18, v16, s[36:39], 0 offen sc1
    s_add_u32 s3, s3, 1
    s_waitcnt vmcnt(0)
    v_cmp_lt_u32 vcc, v18, v17
    s_cmp_gt_u32 s3, 262144
    s_cbranch_scc1 Lpollx_22
    s_cbranch_vccnz Lpoll_21
Lpollx_22:
Lhp_20:
    s_waitcnt lgkmcnt(0)
    s_waitcnt vmcnt(15)
    s_barrier
    s_add_u32 m0, s77, 20480
    s_add_u32 s79, s68, 2048
    buffer_load_dwordx4 v7, s[36:39], s79 offen sc1 lds
    s_add_u32 m0, s77, 21504
    s_add_u32 s79, s69, 3072
    buffer_load_dwordx4 v7, s[36:39], s79 offen sc1 lds
    s_add_u32 m0, s77, 22528
    s_add_u32 s79, s68, 3072
    buffer_load_dwordx4 v7, s[36:39], s79 offen sc1 lds
    s_add_u32 m0, s77, 23552
    s_add_u32 s79, s69, 4096
    buffer_load_dwordx4 v7, s[36:39], s79 offen sc1 lds
    s_add_u32 m0, s77, 40960
    s_add_u32 s79, s68, 4096
    buffer_load_dwordx4 v7, s[36:39], s79 offen sc1 lds
    s_add_u32 m0, s77, 41984
    s_add_u32 s79, s69, 5120
    buffer_load_dwordx4 v7, s[36:39], s79 offen sc1 lds
    s_add_u32 m0, s77, 43008
    s_add_u32 s79, s68, 5120
    buffer_load_dwordx4 v7, s[36:39], s79 offen sc1 lds
    s_add_u32 m0, s77, 44032
    s_add_u32 s79, s69, 6144
    buffer_load_dwordx4 v7, s[36:39], s79 offen sc1 lds
    s_waitcnt vmcnt(4)
    s_barrier
    s_add_u32 m0, s77, 122880
    s_add_u32 s79, s68, 6144
    buffer_load_dwordx4 v7, s[36:39], s79 offen sc1 lds
    s_add_u32 m0, s77, 123904
    s_add_u32 s79, s69, 7168
    buffer_load_dwordx4 v7, s[36:39], s79 offen sc1 lds
    s_add_u32 m0, s77, 124928
    s_add_u32 s79, s68, 7168
    buffer_load_dwordx4 v7, s[36:39], s79 offen sc1 lds
    s_add_u32 m0, s77, 125952
    s_add_u32 s79, s69, 8192
    buffer_load_dwordx4 v7, s[36:39], s79 offen sc1 lds
    s_add_u32 m0, s77, 143360
    s_add_u32 s79, s68, 8192
    buffer_load_dwordx4 v7, s[36:39], s79 offen sc1 lds
    s_barrier
    s_add_u32 m0, s77, 144384
    s_add_u32 s79, s69, 9216
    buffer_load_dwordx4 v7, s[36:39], s79 offen sc1 lds
    s_add_u32 m0, s77, 145408
    s_add_u32 s79, s68, 9216
    buffer_load_dwordx4 v7, s[36:39], s79 offen sc1 lds
    s_add_u32 m0, s77, 146432
    s_add_u32 s79, s69, 10240
    buffer_load_dwordx4 v7, s[36:39], s79 offen sc1 lds
    s_add_u32 m0, s77, 20480
    s_add_u32 s79, s68, 10240
    buffer_load_dwordx4 v7, s[36:39], s79 offen sc1 lds
    s_waitcnt vmcnt(9)
    s_barrier
    s_add_u32 m0, s77, 21504
    s_add_u32 s79, s69, 11264
    buffer_load_dwordx4 v7, s[36:39], s79 offen sc1 lds
    s_add_u32 m0, s77, 22528
    s_add_u32 s79, s68, 11264
    buffer_load_dwordx4 v7, s[36:39], s79 offen sc1 lds
    s_add_u32 m0, s77, 23552
    s_add_u32 s79, s69, 12288
    buffer_load_dwordx4 v7, s[36:39], s79 offen sc1 lds
    s_add_u32 m0, s77, 0
    s_add_u32 s79, s68, 12288
    buffer_load_dwordx4 v7, s[36:39], s79 offen sc1 lds
    s_add_u32 m0, s77, 1024
    s_add_u32 s79, s69, 13312
    buffer_load_dwordx4 v7, s[36:39], s79 offen sc1 lds
    s_waitcnt vmcnt(10)
    s_barrier
    s_add_u32 m0, s77, 2048
    s_add_u32 s79, s68, 13312
    buffer_load_dwordx4 v7, s[36:39], s79 offen sc1 lds
    s_add_u32 m0, s77, 3072
    s_add_u32 s79, s69, 14336
    buffer_load_dwordx4 v7, s[36:39], s79 offen sc1 lds
    s_add_u32 m0, s77, 40960
    s_add_u32 s79, s68, 14336
    buffer_load_dwordx4 v7, s[36:39], s79 offen sc1 lds
    s_add_u32 m0, s77, 41984
    s_add_u32 s79, s69, 15360
    buffer_load_dwordx4 v7, s[36:39], s79 offen sc1 lds
    s_waitcnt vmcnt(10)
    s_barrier
    s_add_u32 m0, s77, 43008
    s_add_u32 s79, s68, 15360
    buffer_load_dwordx4 v7, s[36:39], s79 offen sc1 lds
    s_add_u32 m0, s77, 44032
    s_add_u32 s79, s69, 16384
    buffer_load_dwordx4 v7, s[36:39], s79 offen sc1 lds
    s_add_u32 m0, s80, 61440
    s_add_u32 s79, s78, 81920
    buffer_load_dwordx4 v7, s[36:39], s79 offen sc1 lds
    s_add_u32 m0, s80, 62464
    s_add_u32 s79, s78, 82944
    buffer_load_dwordx4 v7, s[36:39], s79 offen sc1 lds
    s_add_u32 m0, s80, 63488
    s_add_u32 s79, s78, 83968
    buffer_load_dwordx4 v7, s[36:39], s79 offen sc1 lds
    s_waitcnt vmcnt(11)
    s_barrier
    s_add_u32 m0, s80, 64512
    s_add_u32 s79, s78, 84992
    buffer_load_dwordx4 v7, s[36:39], s79 offen sc1 lds
    s_add_u32 m0, s80, 65536
    s_add_u32 s79, s78, 86016
    buffer_load_dwordx4 v7, s[36:39], s79 offen sc1 lds
    s_add_u32 m0, s77, 122880
    s_add_u32 s79, s68, 16384
    buffer_load_dwordx4 v7, s[36:39], s79 offen sc1 lds
    s_add_u32 m0, s77, 123904
    s_add_u32 s79, s69, 17408
    buffer_load_dwordx4 v7, s[36:39], s79 offen sc1 lds
    s_waitcnt vmcnt(11)
    s_barrier
    s_add_u32 m0, s77, 124928
    s_add_u32 s79, s68, 17408
    buffer_load_dwordx4 v7, s[36:39], s79 offen sc1 lds
    s_add_u32 m0, s77, 125952
    s_add_u32 s79, s69, 18432
    buffer_load_dwordx4 v7, s[36:39], s79 offen sc1 lds
    s_add_u32 m0, s77, 20480
    s_add_u32 s79, s68, 18432
    buffer_load_dwordx4 v7, s[36:39], s79 offen sc1 lds
    s_add_u32 m0, s77, 21504
    s_add_u32 s79, s69, 19456
    buffer_load_dwordx4 v7, s[36:39], s79 offen sc1 lds
    s_add_u32 m0, s77, 22528
    s_add_u32 s79, s68, 19456
    buffer_load_dwordx4 v7, s[36:39], s79 offen sc1 lds
    s_waitcnt vmcnt(7)
    s_barrier
    s_add_u32 m0, s77, 23552
    s_add_u32 s79, s69, 20480
    buffer_load_dwordx4 v7, s[36:39], s79 offen sc1 lds
    s_add_u32 m0, s80, 0
    s_add_u32 s79, s78, 102400
    buffer_load_dwordx4 v7, s[36:39], s79 offen sc1 lds
    s_add_u32 m0, s80, 1024
    s_add_u32 s79, s78, 103424
    buffer_load_dwordx4 v7, s[36:39], s79 offen sc1 lds
    s_add_u32 m0, s80, 2048
    s_add_u32 s79, s78, 104448
    buffer_load_dwordx4 v7, s[36:39], s79 offen sc1 lds
    s_add_u32 m0, s80, 3072
    s_add_u32 s79, s78, 105472
    buffer_load_dwordx4 v7, s[36:39], s79 offen sc1 lds
    s_add_u32 m0, s80, 4096
    s_add_u32 s79, s78, 106496
    buffer_load_dwordx4 v7, s[36:39], s79 offen sc1 lds
    s_waitcnt vmcnt(9)
    s_barrier
    s_add_u32 m0, s80, 40960
    s_add_u32 s79, s78, 122880
    buffer_load_dwordx4 v7, s[36:39], s79 offen sc1 lds
    s_add_u32 m0, s80, 41984
    s_add_u32 s79, s78, 123904
    buffer_load_dwordx4 v7, s[36:39], s79 offen sc1 lds
    s_add_u32 m0, s80, 43008
    s_add_u32 s79, s78, 124928
    buffer_load_dwordx4 v7, s[36:39], s79 offen sc1 lds
    s_add_u32 m0, s80, 44032
    s_add_u32 s79, s78, 125952
    buffer_load_dwordx4 v7, s[36:39], s79 offen sc1 lds
    s_add_u32 m0, s80, 45056
    s_add_u32 s79, s78, 126976
    buffer_load_dwordx4 v7, s[36:39], s79 offen sc1 lds
    s_waitcnt vmcnt(5)
    s_barrier
    s_add_u32 m0, s80, 81920
    s_add_u32 s79, s78, 143360
    buffer_load_dwordx4 v7, s[36:39], s79 offen sc1 lds
    s_add_u32 m0, s80, 82944
    s_add_u32 s79, s78, 144384
    buffer_load_dwordx4 v7, s[36:39], s79 offen sc1 lds
    s_add_u32 m0, s80, 83968
    s_add_u32 s79, s78, 145408
    buffer_load_dwordx4 v7, s[36:39], s79 offen sc1 lds
    s_add_u32 m0, s80, 84992
    s_add_u32 s79, s78, 146432
    buffer_load_dwordx4 v7, s[36:39], s79 offen sc1 lds
    s_barrier
    s_add_u32 m0, s80, 86016
    s_add_u32 s79, s78, 147456
    buffer_load_dwordx4 v7, s[36:39], s79 offen sc1 lds
    s_add_u32 m0, s80, 20480
    s_add_u32 s79, s78, 163840
    buffer_load_dwordx4 v7, s[36:39], s79 offen sc1 lds
    s_add_u32 m0, s80, 21504
    s_add_u32 s79, s78, 164864
    buffer_load_dwordx4 v7, s[36:39], s79 offen sc1 lds
    s_add_u32 m0, s80, 22528
    s_add_u32 s79, s78, 165888
    buffer_load_dwordx4 v7, s[36:39], s79 offen sc1 lds
    s_add_u32 m0, s80, 23552
    s_add_u32 s79, s78, 166912
    buffer_load_dwordx4 v7, s[36:39], s79 offen sc1 lds
    s_waitcnt vmcnt(9)
    s_barrier
    s_add_u32 m0, s80, 24576
    s_add_u32 s79, s78, 167936
    buffer_load_dwordx4 v7, s[36:39], s79 offen sc1 lds
    s_add_u32 m0, s80, 61440
    s_add_u32 s79, s78, 184320
    buffer_load_dwordx4 v7, s[36:39], s79 offen sc1 lds
    s_add_u32 m0, s80, 62464
    s_add_u32 s79, s78, 185344
    buffer_load_dwordx4 v7, s[36:39], s79 offen sc1 lds
    s_add_u32 m0, s80, 63488
    s_add_u32 s79, s78, 186368
    buffer_load_dwordx4 v7, s[36:39], s79 offen sc1 lds
    s_barrier
    s_add_u32 m0, s80, 64512
    s_add_u32 s79, s78, 187392
    buffer_load_dwordx4 v7, s[36:39], s79 offen sc1 lds
    s_add_u32 m0, s80, 65536
    s_add_u32 s79, s78, 188416
    buffer_load_dwordx4 v7, s[36:39], s79 offen sc1 lds
    s_add_u32 m0, s80, 0
    s_add_u32 s79, s78, 204800
    buffer_load_dwordx4 v7, s[36:39], s79 offen sc1 lds
    s_add_u32 m0, s80, 1024
    s_add_u32 s79, s78, 205824
    buffer_load_dwordx4 v7, s[36:39], s79 offen sc1 lds
    s_add_u32 m0, s80, 2048
    s_add_u32 s79, s78, 206848
    buffer_load_dwordx4 v7, s[36:39], s79 offen sc1 lds
    s_waitcnt vmcnt(13)
    s_barrier
    s_add_u32 m0, s80, 3072
    s_add_u32 s79, s78, 207872
    buffer_load_dwordx4 v7, s[36:39], s79 offen sc1 lds
    s_add_u32 m0, s80, 4096
    s_add_u32 s79, s78, 208896
    buffer_load_dwordx4 v7, s[36:39], s79 offen sc1 lds
    s_add_u32 m0, s80, 102400
    s_add_u32 s79, s78, 225280
    buffer_load_dwordx4 v7, s[36:39], s79 offen sc1 lds
    s_add_u32 m0, s80, 103424
    s_add_u32 s79, s78, 226304
    buffer_load_dwordx4 v7, s[36:39], s79 offen sc1 lds
    s_barrier
    s_cmp_eq_u32 s44, 4
    s_cbranch_scc0 Lhs_23
    s_mov_b64 exec, 0xffff
    buffer_atomic_add v22, v21, s[36:39], s87 offen offset:4 sc1
    s_mov_b64 exec, -1
Lhs_23:
    s_add_u32 m0, s80, 104448
    s_add_u32 s79, s78, 227328
    buffer_load_dwordx4 v7, s[36:39], s79 offen sc1 lds
    s_add_u32 m0, s80, 105472
    s_add_u32 s79, s78, 228352
    buffer_load_dwordx4 v7, s[36:39], s79 offen sc1 lds
    s_add_u32 m0, s80, 106496
    s_add_u32 s79, s78, 229376
    buffer_load_dwordx4 v7, s[36:39], s79 offen sc1 lds
    s_add_u32 m0, s80, 40960
    s_add_u32 s79, s90, 0
    buffer_load_dwordx4 v7, s[36:39], s79 offen sc1 lds
    s_add_u32 m0, s80, 41984
    s_add_u32 s79, s90, 1024
    buffer_load_dwordx4 v7, s[36:39], s79 offen sc1 lds
    s_waitcnt vmcnt(17)
    s_barrier
    s_add_u32 m0, s80, 43008
    s_add_u32 s79, s90, 2048
    buffer_load_dwordx4 v7, s[36:39], s79 offen sc1 lds
    s_add_u32 m0, s80, 44032
    s_add_u32 s79, s90, 3072
    buffer_load_dwordx4 v7, s[36:39], s79 offen sc1 lds
    s_add_u32 m0, s80, 45056
    s_add_u32 s79, s90, 4096
    buffer_load_dwordx4 v7, s[36:39], s79 offen sc1 lds
    s_add_u32 m0, s80, 122880
    s_add_u32 s79, s91, 0
    buffer_load_dwordx4 v7, s[36:39], s79 offen sc1 lds
    s_barrier
    s_add_u32 m0, s80, 123904
    s_add_u32 s79, s91, 1024
    buffer_load_dwordx4 v7, s[36:39], s79 offen sc1 lds
    s_add_u32 m0, s80, 124928
    s_add_u32 s79, s91, 2048
    buffer_load_dwordx4 v7, s[36:39], s79 offen sc1 lds
    s_add_u32 m0, s80, 125952
    s_add_u32 s79, s91, 3072
    buffer_load_dwordx4 v7, s[36:39], s79 offen sc1 lds
    s_add_u32 m0, s80, 126976
    s_add_u32 s79, s91, 4096
    buffer_load_dwordx4 v7, s[36:39], s79 offen sc1 lds
    s_add_u32 m0, s80, 81920
    s_add_u32 s79, s92, 0
    buffer_load_dwordx4 v7, s[36:39], s79 offen sc1 lds
    s_waitcnt vmcnt(21)
    s_barrier
    s_add_u32 m0, s80, 82944
    s_add_u32 s79, s92, 1024
    buffer_load_dwordx4 v7, s[36:39], s79 offen sc1 lds
    s_add_u32 m0, s80, 83968
    s_add_u32 s79, s92, 2048
    buffer_load_dwordx4 v7, s[36:39], s79 offen sc1 lds
    s_add_u32 m0, s80, 84992
    s_add_u32 s79, s92, 3072
    buffer_load_dwordx4 v7, s[36:39], s79 offen sc1 lds
    s_add_u32 m0, s80, 86016
    s_add_u32 s79, s92, 4096
    buffer_load_dwordx4 v7, s[36:39], s79 offen sc1 lds
    s_barrier
    buffer_load_dword v24, off, s[36:39], s88 offset:28 sc1
    s_add_u32 m0, s80, 20480
    s_add_u32 s79, s93, 0
    buffer_load_dwordx4 v7, s[36:39], s79 offen sc1 lds
    s_add_u32 m0, s80, 21504
    s_add_u32 s79, s93, 1024
    buffer_load_dwordx4 v7, s[36:39], s79 offen sc1 lds
    s_add_u32 m0, s80, 22528
    s_add_u32 s79, s93, 2048
    buffer_load_dwordx4 v7, s[36:39], s79 offen sc1 lds
    s_add_u32 m0, s80, 23552
    s_add_u32 s79, s93, 3072
    buffer_load_dwordx4 v7, s[36:39], s79 offen sc1 lds
    s_add_u32 m0, s80, 24576
    s_add_u32 s79, s93, 4096
    buffer_load_dwordx4 v7, s[36:39], s79 offen sc1 lds
    s_waitcnt vmcnt(26)
    s_barrier
    s_cmp_eq_u32 s44, 4
    s_cbranch_scc0 Lhs_24
    s_mov_b64 exec, 0xffff
    buffer_atomic_add v22, v21, s[36:39], 0 offen offset:8 sc1
    s_mov_b64 exec, -1
Lhs_24:
    s_add_u32 m0, s80, 143360
    s_add_u32 s79, s90, 81920
    buffer_load_dwordx4 v7, s[36:39], s79 offen sc1 lds
    s_add_u32 m0, s80, 144384
    s_add_u32 s79, s90, 82944
    buffer_load_dwordx4 v7, s[36:39], s79 offen sc1 lds
    s_add_u32 m0, s80, 145408
    s_add_u32 s79, s90, 83968
    buffer_load_dwordx4 v7, s[36:39], s79 offen sc1 lds
    s_add_u32 m0, s80, 146432
    s_add_u32 s79, s90, 84992
    buffer_load_dwordx4 v7, s[36:39], s79 offen sc1 lds
    s_waitcnt vmcnt(9)
    v_readfirstlane_b32 s4, v24
    s_nop 0
    s_cmp_ge_u32 s4, 16
    s_cbranch_scc1 Lhq_25
    s_cmp_eq_u32 s44, 7
    s_cbranch_scc0 Lhp_26
    v_mov_b32 v17, 0
    v_writelane_b32 v17, 16, 23
    s_mov_b32 s3, 0
Lpoll_27:
    buffer_load_dword v18, v16, s[36:39], 0 offen sc1
    s_add_u32 s3, s3, 1
    s_waitcnt vmcnt(0)
    v_cmp_lt_u32 vcc, v18, v17
    s_cmp_gt_u32 s3, 262144
    s_cbranch_scc1 Lpollx_28
    s_cbranch_vccnz Lpoll_27
Lpollx_28:
Lhp_26:
Lhq_25:
    s_barrier
    s_add_u32 m0, s80, 147456
    s_add_u32 s79, s90, 86016
    buffer_load_dwordx4 v7, s[36:39], s79 offen sc1 lds
    s_barrier
    s_barrier
    s_add_u32 m0, s80, 0
    s_add_u32 s79, s91, 81920
    buffer_load_dwordx4 v7, s[36:39], s79 offen sc1 lds
    s_barrier
    buffer_load_dword v25, off, s[36:39], s76 offset:32 sc1
    s_add_u32 m0, s80, 1024
    s_add_u32 s79, s91, 82944
    buffer_load_dwordx4 v7, s[36:39], s79 offen sc1 lds
    s_add_u32 m0, s80, 2048
    s_add_u32 s79, s91, 83968
    buffer_load_dwordx4 v7, s[36:39], s79 offen sc1 lds
    s_add_u32 m0, s80, 3072
    s_add_u32 s79, s91, 84992
    buffer_load_dwordx4 v7, s[36:39], s79 offen sc1 lds
    s_add_u32 m0, s80, 4096
    s_add_u32 s79, s91, 86016
    buffer_load_dwordx4 v7, s[36:39], s79 offen sc1 lds
    s_add_u32 m0, s80, 61440
    s_add_u32 s79, s92, 81920
    buffer_load_dwordx4 v7, s[36:39], s79 offen sc1 lds
    s_add_u32 m0, s80, 62464
    s_add_u32 s79, s92, 82944
    buffer_load_dwordx4 v7, s[36:39], s79 offen sc1 lds
    s_add_u32 m0, s80, 63488
    s_add_u32 s79, s92, 83968
    buffer_load_dwordx4 v7, s[36:39], s79 offen sc1 lds
    s_add_u32 m0, s80, 64512
    s_add_u32 s79, s92, 84992
    buffer_load_dwordx4 v7, s[36:39], s79 offen sc1 lds
    s_barrier
    s_add_u32 m0, s80, 65536
    s_add_u32 s79, s92, 86016
    buffer_load_dwordx4 v7, s[36:39], s79 offen sc1 lds
    s_add_u32 m0, s80, 102400
    s_add_u32 s79, s93, 81920
    buffer_load_dwordx4 v7, s[36:39], s79 offen sc1 lds
    s_add_u32 m0, s80, 103424
    s_add_u32 s79, s93, 82944
    buffer_load_dwordx4 v7, s[36:39], s79 offen sc1 lds
    s_add_u32 m0, s80, 104448
    s_add_u32 s79, s93, 83968
    buffer_load_dwordx4 v7, s[36:39], s79 offen sc1 lds
    s_add_u32 m0, s80, 105472
    s_add_u32 s79, s93, 84992
    buffer_load_dwordx4 v7, s[36:39], s79 offen sc1 lds
    s_add_u32 m0, s80, 106496
    s_add_u32 s79, s93, 86016
    buffer_load_dwordx4 v7, s[36:39], s79 offen sc1 lds
    s_waitcnt vmcnt(14)
    v_readfirstlane_b32 s4, v25
    s_nop 0
    s_cmp_ge_u32 s4, 16
    s_cbranch_scc1 Lhq_29
    s_cmp_eq_u32 s44, 7
    s_cbranch_scc0 Lhp_30
    v_mov_b32 v17, 0
    v_writelane_b32 v17, 16, 8
    s_mov_b32 s3, 0
Lpoll_31:
    buffer_load_dword v18, v16, s[36:39], 0 offen sc1
    s_add_u32 s3, s3, 1
    s_waitcnt vmcnt(0)
    v_cmp_lt_u32 vcc, v18, v17
    s_cmp_gt_u32 s3, 262144
    s_cbranch_scc1 Lpollx_32
    s_cbranch_vccnz Lpoll_31
Lpollx_32:
Lhp_30:
Lhq_29:
    s_barrier
    s_cmp_eq_u32 s44, 4
    s_cbranch_scc0 Lhs_33
    s_mov_b64 exec, 0xffff
    buffer_atomic_add v22, v21, s[36:39], s87 offen offset:12 sc1
    s_mov_b64 exec, -1
Lhs_33:
    s_add_u32 m0, s80, 40960
    s_add_u32 s79, s90, 163840
    buffer_load_dwordx4 v7, s[36:39], s79 offen sc1 lds
    s_add_u32 m0, s80, 41984
    s_add_u32 s79, s90, 164864
    buffer_load_dwordx4 v7, s[36:39], s79 offen sc1 lds
    s_barrier
    s_add_u32 m0, s80, 43008
    s_add_u32 s79, s90, 165888
    buffer_load_dwordx4 v7, s[36:39], s79 offen sc1 lds
    s_add_u32 m0, s80, 44032
    s_add_u32 s79, s90, 166912
    buffer_load_dwordx4 v7, s[36:39], s79 offen sc1 lds
    s_add_u32 m0, s80, 45056
    s_add_u32 s79, s90, 167936
    buffer_load_dwordx4 v7, s[36:39], s79 offen sc1 lds
    s_add_u32 m0, s80, 122880
    s_add_u32 s79, s91, 163840
    buffer_load_dwordx4 v7, s[36:39], s79 offen sc1 lds
    s_add_u32 m0, s80, 123904
    s_add_u32 s79, s91, 164864
    buffer_load_dwordx4 v7, s[36:39], s79 offen sc1 lds
    s_add_u32 m0, s80, 124928
    s_add_u32 s79, s91, 165888
    buffer_load_dwordx4 v7, s[36:39], s79 offen sc1 lds
    s_barrier
    s_add_u32 m0, s80, 125952
    s_add_u32 s79, s91, 166912
    buffer_load_dwordx4 v7, s[36:39], s79 offen sc1 lds
    s_add_u32 m0, s80, 126976
    s_add_u32 s79, s91, 167936
    buffer_load_dwordx4 v7, s[36:39], s79 offen sc1 lds
    s_add_u32 m0, s80, 81920
    s_add_u32 s79, s92, 163840
    buffer_load_dwordx4 v7, s[36:39], s79 offen sc1 lds
    s_add_u32 m0, s80, 82944
    s_add_u32 s79, s92, 164864
    buffer_load_dwordx4 v7, s[36:39], s79 offen sc1 lds
    s_add_u32 m0, s80, 83968
    s_add_u32 s79, s92, 165888
    buffer_load_dwordx4 v7, s[36:39], s79 offen sc1 lds
    s_add_u32 m0, s80, 84992
    s_add_u32 s79, s92, 166912
    buffer_load_dwordx4 v7, s[36:39], s79 offen sc1 lds
    s_add_u32 m0, s80, 86016
    s_add_u32 s79, s92, 167936
    buffer_load_dwordx4 v7, s[36:39], s79 offen sc1 lds
    s_waitcnt vmcnt(25)
    s_barrier
    s_add_u32 m0, s80, 20480
    s_add_u32 s79, s93, 163840
    buffer_load_dwordx4 v7, s[36:39], s79 offen sc1 lds
    s_add_u32 m0, s80, 21504
    s_add_u32 s79, s93, 164864
    buffer_load_dwordx4 v7, s[36:39], s79 offen sc1 lds
    s_add_u32 m0, s80, 22528
    s_add_u32 s79, s93, 165888
    buffer_load_dwordx4 v7, s[36:39], s79 offen sc1 lds
    s_add_u32 m0, s80, 23552
    s_add_u32 s79, s93, 166912
    buffer_load_dwordx4 v7, s[36:39], s79 offen sc1 lds
    s_add_u32 m0, s80, 24576
    s_add_u32 s79, s93, 167936
    buffer_load_dwordx4 v7, s[36:39], s79 offen sc1 lds
    s_waitcnt vmcnt(25)
    s_barrier
    buffer_load_dword v26, off, s[36:39], s88 offset:36 sc1
    s_waitcnt vmcnt(21)
    s_waitcnt vmcnt(0)
    v_readfirstlane_b32 s4, v26
    s_nop 0
    s_cmp_ge_u32 s4, 16
    s_cbranch_scc1 Lhq_34
    s_cmp_eq_u32 s44, 7
    s_cbranch_scc0 Lhp_35
    v_mov_b32 v17, 0
    v_writelane_b32 v17, 16, 25
    s_mov_b32 s3, 0
Lpoll_36:
    buffer_load_dword v18, v16, s[36:39], 0 offen sc1
    s_add_u32 s3, s3, 1
    s_waitcnt vmcnt(0)
    v_cmp_lt_u32 vcc, v18, v17
    s_cmp_gt_u32 s3, 262144
    s_cbranch_scc1 Lpollx_37
    s_cbranch_vccnz Lpoll_36
Lpollx_37:
Lhp_35:
Lhq_34:
    s_barrier
    s_barrier
    ds_write_b64 v9, v[32:33] offset:0
    ds_write_b64 v9, v[34:35] offset:512
    ds_write_b64 v9, v[36:37] offset:1024
    ds_write_b64 v9, v[38:39] offset:1536
    ds_write_b64 v9, v[40:41] offset:2048
    s_barrier
    s_barrier
    s_waitcnt lgkmcnt(0)
    s_barrier
L_fin:
    s_endpgm
L_att_slow:
    s_waitcnt vmcnt(0)
    s_cmp_ge_u32 s44, 4
    s_cbranch_scc0 L_slow_ns
    buffer_store_dwordx4 v[136:139], v155, s[36:39], 0 offen offset:0 sc1
    buffer_store_dwordx4 v[148:151], v159, s[36:39], 0 offen offset:0 sc1
L_slow_ns:
    v_lshrrev_b32 v2, 5, v1
    v_and_b32 v3, 31, v1
    v_lshlrev_b32 v4, 2, v2
    v_sub_u32 v4, v3, v4
    v_cmp_le_i32 s[62:63], 0, v4
    v_cmp_le_i32 s[64:65], 1, v4
    v_cmp_le_i32 s[66:67], 2, v4
    v_cmp_le_i32 s[68:69], 3, v4
    v_cmp_le_i32 s[70:71], 8, v4
    v_cmp_le_i32 s[72:73], 9, v4
    v_cmp_le_i32 s[74:75], 10, v4
    v_cmp_le_i32 s[76:77], 11, v4
    v_cmp_le_i32 s[78:79], 16, v4
    v_cmp_le_i32 s[80:81], 17, v4
    v_cmp_le_i32 s[82:83], 18, v4
    v_cmp_le_i32 s[84:85], 19, v4
    v_cmp_le_i32 s[86:87], 24, v4
    v_cmp_le_i32 s[88:89], 25, v4
    v_cmp_le_i32 s[90:91], 26, v4
    v_cmp_le_i32 s[92:93], 27, v4
    v_mov_b32 v5, 0xffff
    v_mov_b32 v6, 0xffff0000
    v_cndmask_b32 v224, 0, v5, s[62:63]
    v_cndmask_b32 v7, 0, v6, s[64:65]
    v_or_b32 v224, v224, v7
    v_cndmask_b32 v225, 0, v5, s[66:67]
    v_cndmask_b32 v7, 0, v6, s[68:69]
    v_or_b32 v225, v225, v7
    v_cndmask_b32 v226, 0, v5, s[70:71]
    v_cndmask_b32 v7, 0, v6, s[72:73]
    v_or_b32 v226, v226, v7
    v_cndmask_b32 v227, 0, v5, s[74:75]
    v_cndmask_b32 v7, 0, v6, s[76:77]
    v_or_b32 v227, v227, v7
    v_cndmask_b32 v228, 0, v5, s[78:79]
    v_cndmask_b32 v7, 0, v6, s[80:81]
    v_or_b32 v228, v228, v7
    v_cndmask_b32 v229, 0, v5, s[82:83]
    v_cndmask_b32 v7, 0, v6, s[84:85]
    v_or_b32 v229, v229, v7
    v_cndmask_b32 v230, 0, v5, s[86:87]
    v_cndmask_b32 v7, 0, v6, s[88:89]
    v_or_b32 v230, v230, v7
    v_cndmask_b32 v231, 0, v5, s[90:91]
    v_cndmask_b32 v7, 0, v6, s[92:93]
    v_or_b32 v231, v231, v7
    ds_read_b64 v[32:33], v8 offset:0
    ds_read_b64 v[34:35], v8 offset:8192
    ds_read_b64 v[36:37], v8 offset:16384
    ds_read_b64 v[38:39], v8 offset:2048
    ds_read_b64 v[40:41], v8 offset:10240
    ds_read_b64 v[42:43], v8 offset:18432
    ds_read_b64 v[44:45], v8 offset:256
    ds_read_b64 v[46:47], v8 offset:8448
    ds_read_b64 v[48:49], v8 offset:16640
    s_waitcnt lgkmcnt(6)
    v_mfma_f32_32x32x16_bf16 v[64:79], v[32:35], v[24:27], 0
    v_mfma_f32_32x32x8_bf16 v[64:79], v[36:37], v[28:29], v[64:79]
    ds_read_b64 v[32:33], v8 offset:512
    ds_read_b64 v[34:35], v8 offset:8704
    ds_read_b64 v[36:37], v8 offset:16896
    s_waitcnt lgkmcnt(6)
    v_mfma_f32_32x32x16_bf16 v[192:207], v[38:41], v[24:27], 0
    v_mfma_f32_32x32x8_bf16 v[192:207], v[42:43], v[28:29], v[192:207]
    ds_read_b64 v[38:39], v8 offset:768
    ds_read_b64 v[40:41], v8 offset:8960
    ds_read_b64 v[42:43], v8 offset:17152
    s_waitcnt lgkmcnt(6)
    v_mfma_f32_32x32x16_bf16 v[80:95], v[44:47], v[24:27], 0
    v_mfma_f32_32x32x8_bf16 v[80:95], v[48:49], v[28:29], v[80:95]
    ds_read_b64 v[44:45], v8 offset:1024
    ds_read_b64 v[46:47], v8 offset:9216
    ds_read_b64 v[48:49], v8 offset:17408
    s_waitcnt lgkmcnt(6)
    v_mfma_f32_32x32x16_bf16 v[96:111], v[32:35], v[24:27], 0
    s_nop 0
    v_cndmask_b32 v192, v64, v192, s[62:63]
    v_cndmask_b32 v193, v65, v193, s[64:65]
    v_cndmask_b32 v194, v66, v194, s[66:67]
    v_cndmask_b32 v195, v67, v195, s[68:69]
    v_cndmask_b32 v196, v68, v196, s[70:71]
    v_cndmask_b32 v197, v69, v197, s[72:73]
    v_mfma_f32_32x32x8_bf16 v[96:111], v[36:37], v[28:29], v[96:111]
    v_cndmask_b32 v198, v70, v198, s[74:75]
    v_cndmask_b32 v199, v71, v199, s[76:77]
    v_cndmask_b32 v200, v72, v200, s[78:79]
    v_cndmask_b32 v201, v73, v201, s[80:81]
    v_cndmask_b32 v202, v74, v202, s[82:83]
    v_cndmask_b32 v203, v75, v203, s[84:85]
    ds_read_b64 v[32:33], v8 offset:1280
    ds_read_b64 v[34:35], v8 offset:9472
    ds_read_b64 v[36:37], v8 offset:17664
    s_waitcnt lgkmcnt(6)
    v_mfma_f32_32x32x16_bf16 v[112:127], v[38:41], v[24:27], 0
    v_cndmask_b32 v204, v76, v204, s[86:87]
    v_cndmask_b32 v205, v77, v205, s[88:89]
    v_cndmask_b32 v206, v78, v206, s[90:91]
    v_cndmask_b32 v207, v79, v207, s[92:93]
    v_max_f32 v14, v192, v193
    v_max_f32 v15, v194, v195
    v_mfma_f32_32x32x8_bf16 v[112:127], v[42:43], v[28:29], v[112:127]
    v_max3_f32 v14, v196, v197, v14
    v_max3_f32 v15, v198, v199, v15
    v_max3_f32 v14, v200, v201, v14
    v_max3_f32 v15, v202, v203, v15
    v_max3_f32 v14, v204, v205, v14
    v_max3_f32 v15, v206, v207, v15
    ds_read_b64 v[38:39], v8 offset:1536
    ds_read_b64 v[40:41], v8 offset:9728
    ds_read_b64 v[42:43], v8 offset:17920
    s_waitcnt lgkmcnt(6)
    v_mfma_f32_32x32x16_bf16 v[128:143], v[44:47], v[24:27], 0
    v_max3_f32 v14, v80, v81, v14
    v_max3_f32 v15, v82, v83, v15
    v_max3_f32 v14, v84, v85, v14
    v_max3_f32 v15, v86, v87, v15
    v_max3_f32 v14, v88, v89, v14
    v_max3_f32 v15, v90, v91, v15
    v_mfma_f32_32x32x8_bf16 v[128:143], v[48:49], v[28:29], v[128:143]
    v_max3_f32 v14, v92, v93, v14
    v_max3_f32 v15, v94, v95, v15
    v_max3_f32 v14, v96, v97, v14
    v_max3_f32 v15, v98, v99, v15
    v_max3_f32 v14, v100, v101, v14
    v_max3_f32 v15, v102, v103, v15
    ds_read_b64 v[44:45], v8 offset:1792
    ds_read_b64 v[46:47], v8 offset:9984
    ds_read_b64 v[48:49], v8 offset:18176
    s_waitcnt lgkmcnt(6)
    v_mfma_f32_32x32x16_bf16 v[144:159], v[32:35], v[24:27], 0
    v_max3_f32 v14, v104, v105, v14
    v_max3_f32 v15, v106, v107, v15
    v_max3_f32 v14, v108, v109, v14
    v_max3_f32 v15, v110, v111, v15
    v_max3_f32 v14, v112, v113, v14
    v_max3_f32 v15, v114, v115, v15
    v_mfma_f32_32x32x8_bf16 v[144:159], v[36:37], v[28:29], v[144:159]
    v_max3_f32 v14, v116, v117, v14
    v_max3_f32 v15, v118, v119, v15
    v_max3_f32 v14, v120, v121, v14
    v_max3_f32 v15, v122, v123, v15
    v_max3_f32 v14, v124, v125, v14
    v_max3_f32 v15, v126, v127, v15
    s_waitcnt lgkmcnt(3)
    v_mfma_f32_32x32x16_bf16 v[160:175], v[38:41], v[24:27], 0
    v_max3_f32 v14, v128, v129, v14
    v_max3_f32 v15, v130, v131, v15
    v_max3_f32 v14, v132, v133, v14
    v_max3_f32 v15, v134, v135, v15
    v_max3_f32 v14, v136, v137, v14
    v_max3_f32 v15, v138, v139, v15
    v_mfma_f32_32x32x8_bf16 v[160:175], v[42:43], v[28:29], v[160:175]
    v_max3_f32 v14, v140, v141, v14
    v_max3_f32 v15, v142, v143, v15
    s_waitcnt lgkmcnt(0)
    v_mfma_f32_32x32x16_bf16 v[176:191], v[44:47], v[24:27], 0
    v_max3_f32 v14, v144, v145, v14
    v_max3_f32 v15, v146, v147, v15
    v_max3_f32 v14, v148, v149, v14
    v_max3_f32 v15, v150, v151, v15
    v_max3_f32 v14, v152, v153, v14
    v_max3_f32 v15, v154, v155, v15
    v_mfma_f32_32x32x8_bf16 v[176:191], v[48:49], v[28:29], v[176:191]
    v_max3_f32 v14, v156, v157, v14
    v_max3_f32 v15, v158, v159, v15
    ds_read_b64_tr_b16 v[50:51], v9 offset:2048
    ds_read_b64_tr_b16 v[52:53], v9 offset:2112
    ds_read_b64_tr_b16 v[54:55], v9 offset:2176
    ds_read_b64_tr_b16 v[56:57], v9 offset:2240
    ds_read_b64_tr_b16 v[58:59], v9 offset:0
    ds_read_b64_tr_b16 v[60:61], v9 offset:64
    v_max3_f32 v14, v160, v161, v14
    v_max3_f32 v15, v162, v163, v15
    v_max3_f32 v14, v164, v165, v14
    v_max3_f32 v15, v166, v167, v15
    v_max3_f32 v14, v168, v169, v14
    v_max3_f32 v15, v170, v171, v15
    v_max3_f32 v14, v172, v173, v14
    v_max3_f32 v15, v174, v175, v15
    v_max3_f32 v14, v176, v177, v14
    v_max3_f32 v15, v178, v179, v15
    v_max3_f32 v14, v180, v181, v14
    v_max3_f32 v15, v182, v183, v15
    v_max3_f32 v14, v184, v185, v14
    v_max3_f32 v15, v186, v187, v15
    v_max3_f32 v14, v188, v189, v14
    v_max3_f32 v15, v190, v191, v15
    v_max_f32 v14, v14, v15
    v_mov_b32 v15, v14
    s_nop 1
    v_permlane32_swap_b32 v14, v15
    v_max_f32 v14, v14, v15
    v_sub_f32 v14, 0, v14
    v_cvt_pk_bf16_f32 v15, v14, v14
    v_and_b32 v15, 0xffff0000, v15
    v_sub_f32 v14, v14, v15
    v_cvt_pk_bf16_f32 v22, v15, v14
    v_and_b32 v15, 0xffff0000, v22
    v_sub_f32 v14, v14, v15
    v_cvt_pk_bf16_f32 v23, v14, 0
    s_nop 1
    v_mfma_f32_32x32x8_bf16 v[192:207], v[30:31], v[22:23], v[192:207]
    v_mfma_f32_32x32x8_bf16 v[80:95], v[30:31], v[22:23], v[80:95]
    s_nop 10
    v_exp_f32 v192, v192
    v_exp_f32 v193, v193
    v_exp_f32 v194, v194
    v_mfma_f32_32x32x8_bf16 v[96:111], v[30:31], v[22:23], v[96:111]
    v_exp_f32 v195, v195
    v_exp_f32 v196, v196
    v_exp_f32 v197, v197
    v_exp_f32 v198, v198
    v_exp_f32 v199, v199
    v_cvt_pk_bf16_f32 v192, v192, v193
    v_cvt_pk_bf16_f32 v193, v194, v195
    v_cvt_pk_bf16_f32 v194, v196, v197
    v_cvt_pk_bf16_f32 v195, v198, v199
    v_and_b32 v16, v224, v192
    v_xor_b32 v64, v16, v192
    v_mov_b32 v192, v16
    v_and_b32 v16, v225, v193
    v_xor_b32 v65, v16, v193
    v_mov_b32 v193, v16
    v_and_b32 v16, v226, v194
    v_xor_b32 v66, v16, v194
    v_mov_b32 v194, v16
    v_and_b32 v16, v227, v195
    v_xor_b32 v67, v16, v195
    v_mov_b32 v195, v16
    v_exp_f32 v200, v200
    v_exp_f32 v201, v201
    v_exp_f32 v202, v202
    v_exp_f32 v203, v203
    v_exp_f32 v204, v204
    s_waitcnt lgkmcnt(4)
    v_mfma_f32_32x32x16_bf16 v[208:223], v[50:53], v[192:195], 0
    ds_read_b64_tr_b16 v[50:51], v9 offset:128
    ds_read_b64_tr_b16 v[52:53], v9 offset:192
    v_exp_f32 v205, v205
    v_exp_f32 v206, v206
    v_exp_f32 v207, v207
    v_cvt_pk_bf16_f32 v200, v200, v201
    v_cvt_pk_bf16_f32 v201, v202, v203
    v_cvt_pk_bf16_f32 v202, v204, v205
    v_cvt_pk_bf16_f32 v203, v206, v207
    v_and_b32 v16, v228, v200
    v_xor_b32 v72, v16, v200
    v_mov_b32 v200, v16
    v_and_b32 v16, v229, v201
    v_xor_b32 v73, v16, v201
    v_mov_b32 v201, v16
    v_and_b32 v16, v230, v202
    v_xor_b32 v74, v16, v202
    v_mov_b32 v202, v16
    v_and_b32 v16, v231, v203
    v_xor_b32 v75, v16, v203
    v_mov_b32 v203, v16
    v_exp_f32 v80, v80
    v_exp_f32 v81, v81
    v_exp_f32 v82, v82
    v_mfma_f32_32x32x8_bf16 v[112:127], v[30:31], v[22:23], v[112:127]
    v_exp_f32 v83, v83
    v_exp_f32 v84, v84
    s_waitcnt lgkmcnt(4)
    v_mfma_f32_32x32x16_bf16 v[208:223], v[54:57], v[200:203], v[208:223]
    ds_read_b64_tr_b16 v[54:55], v9 offset:256
    ds_read_b64_tr_b16 v[56:57], v9 offset:320
    v_exp_f32 v85, v85
    v_exp_f32 v86, v86
    v_exp_f32 v87, v87
    s_waitcnt lgkmcnt(4)
    v_mfma_f32_32x32x16_bf16 v[208:223], v[58:61], v[64:67], v[208:223]
    ds_read_b64_tr_b16 v[58:59], v9 offset:384
    ds_read_b64_tr_b16 v[60:61], v9 offset:448
    v_cvt_pk_bf16_f32 v80, v80, v81
    v_cvt_pk_bf16_f32 v81, v82, v83
    v_cvt_pk_bf16_f32 v82, v84, v85
    v_cvt_pk_bf16_f32 v83, v86, v87
    v_exp_f32 v88, v88
    v_exp_f32 v89, v89
    v_exp_f32 v90, v90
    v_exp_f32 v91, v91
    v_exp_f32 v92, v92
    s_waitcnt lgkmcnt(4)
    v_mfma_f32_32x32x16_bf16 v[208:223], v[50:53], v[72:75], v[208:223]
    ds_read_b64_tr_b16 v[50:51], v9 offset:512
    ds_read_b64_tr_b16 v[52:53], v9 offset:576
    v_exp_f32 v93, v93
    v_exp_f32 v94, v94
    v_exp_f32 v95, v95
    v_cvt_pk_bf16_f32 v88, v88, v89
    v_cvt_pk_bf16_f32 v89, v90, v91
    v_cvt_pk_bf16_f32 v90, v92, v93
    v_cvt_pk_bf16_f32 v91, v94, v95
    v_exp_f32 v96, v96
    v_exp_f32 v97, v97
    v_exp_f32 v98, v98
    v_mfma_f32_32x32x8_bf16 v[128:143], v[30:31], v[22:23], v[128:143]
    v_exp_f32 v99, v99
    v_exp_f32 v100, v100
    s_waitcnt lgkmcnt(4)
    v_mfma_f32_32x32x16_bf16 v[208:223], v[54:57], v[80:83], v[208:223]
    ds_read_b64_tr_b16 v[54:55], v9 offset:640
    ds_read_b64_tr_b16 v[56:57], v9 offset:704
    v_exp_f32 v101, v101
    v_exp_f32 v102, v102
    v_exp_f32 v103, v103
    v_cvt_pk_bf16_f32 v96, v96, v97
    v_cvt_pk_bf16_f32 v97, v98, v99
    v_cvt_pk_bf16_f32 v98, v100, v101
    v_cvt_pk_bf16_f32 v99, v102, v103
    v_exp_f32 v104, v104
    v_exp_f32 v105, v105
    v_exp_f32 v106, v106
    v_exp_f32 v107, v107
    v_exp_f32 v108, v108
    s_waitcnt lgkmcnt(4)
    v_mfma_f32_32x32x16_bf16 v[208:223], v[58:61], v[88:91], v[208:223]
    ds_read_b64_tr_b16 v[58:59], v9 offset:768
    ds_read_b64_tr_b16 v[60:61], v9 offset:832
    v_exp_f32 v109, v109
    v_exp_f32 v110, v110
    v_exp_f32 v111, v111
    v_cvt_pk_bf16_f32 v104, v104, v105
    v_cvt_pk_bf16_f32 v105, v106, v107
    v_cvt_pk_bf16_f32 v106, v108, v109
    v_cvt_pk_bf16_f32 v107, v110, v111
    v_exp_f32 v112, v112
    v_exp_f32 v113, v113
    v_exp_f32 v114, v114
    v_mfma_f32_32x32x8_bf16 v[144:159], v[30:31], v[22:23], v[144:159]
    v_exp_f32 v115, v115
    v_exp_f32 v116, v116
    s_waitcnt lgkmcnt(4)
    v_mfma_f32_32x32x16_bf16 v[208:223], v[50:53], v[96:99], v[208:223]
    ds_read_b64_tr_b16 v[50:51], v9 offset:896
    ds_read_b64_tr_b16 v[52:53], v9 offset:960
    v_exp_f32 v117, v117
    v_exp_f32 v118, v118
    v_exp_f32 v119, v119
    v_cvt_pk_bf16_f32 v112, v112, v113
    v_cvt_pk_bf16_f32 v113, v114, v115
    v_cvt_pk_bf16_f32 v114, v116, v117
    v_cvt_pk_bf16_f32 v115, v118, v119
    v_exp_f32 v120, v120
    v_exp_f32 v121, v121
    v_exp_f32 v122, v122
    v_exp_f32 v123, v123
    v_exp_f32 v124, v124
    s_waitcnt lgkmcnt(4)
    v_mfma_f32_32x32x16_bf16 v[208:223], v[54:57], v[104:107], v[208:223]
    ds_read_b64_tr_b16 v[54:55], v9 offset:1024
    ds_read_b64_tr_b16 v[56:57], v9 offset:1088
    v_exp_f32 v125, v125
    v_exp_f32 v126, v126
    v_exp_f32 v127, v127
    v_cvt_pk_bf16_f32 v120, v120, v121
    v_cvt_pk_bf16_f32 v121, v122, v123
    v_cvt_pk_bf16_f32 v122, v124, v125
    v_cvt_pk_bf16_f32 v123, v126, v127
    v_exp_f32 v128, v128
    v_exp_f32 v129, v129
    v_exp_f32 v130, v130
    v_mfma_f32_32x32x8_bf16 v[160:175], v[30:31], v[22:23], v[160:175]
    v_exp_f32 v131, v131
    v_exp_f32 v132, v132
    s_waitcnt lgkmcnt(4)
    v_mfma_f32_32x32x16_bf16 v[208:223], v[58:61], v[112:115], v[208:223]
    ds_read_b64_tr_b16 v[58:59], v9 offset:1152
    ds_read_b64_tr_b16 v[60:61], v9 offset:1216
    v_exp_f32 v133, v133
    v_exp_f32 v134, v134
    v_exp_f32 v135, v135
    v_cvt_pk_bf16_f32 v128, v128, v129
    v_cvt_pk_bf16_f32 v129, v130, v131
    v_cvt_pk_bf16_f32 v130, v132, v133
    v_cvt_pk_bf16_f32 v131, v134, v135
    v_exp_f32 v136, v136
    v_exp_f32 v137, v137
    v_exp_f32 v138, v138
    v_exp_f32 v139, v139
    v_exp_f32 v140, v140
    s_waitcnt lgkmcnt(4)
    v_mfma_f32_32x32x16_bf16 v[208:223], v[50:53], v[120:123], v[208:223]
    ds_read_b64_tr_b16 v[50:51], v9 offset:1280
    ds_read_b64_tr_b16 v[52:53], v9 offset:1344
    v_exp_f32 v141, v141
    v_exp_f32 v142, v142
    v_exp_f32 v143, v143
    v_cvt_pk_bf16_f32 v136, v136, v137
    v_cvt_pk_bf16_f32 v137, v138, v139
    v_cvt_pk_bf16_f32 v138, v140, v141
    v_cvt_pk_bf16_f32 v139, v142, v143
    v_exp_f32 v144, v144
    v_exp_f32 v145, v145
    v_exp_f32 v146, v146
    v_mfma_f32_32x32x8_bf16 v[176:191], v[30:31], v[22:23], v[176:191]
    v_exp_f32 v147, v147
    v_exp_f32 v148, v148
    s_waitcnt lgkmcnt(4)
    v_mfma_f32_32x32x16_bf16 v[208:223], v[54:57], v[128:131], v[208:223]
    ds_read_b64_tr_b16 v[54:55], v9 offset:1408
    ds_read_b64_tr_b16 v[56:57], v9 offset:1472
    v_exp_f32 v149, v149
    v_exp_f32 v150, v150
    v_exp_f32 v151, v151
    v_cvt_pk_bf16_f32 v144, v144, v145
    v_cvt_pk_bf16_f32 v145, v146, v147
    v_cvt_pk_bf16_f32 v146, v148, v149
    v_cvt_pk_bf16_f32 v147, v150, v151
    v_exp_f32 v152, v152
    v_exp_f32 v153, v153
    v_exp_f32 v154, v154
    v_exp_f32 v155, v155
    v_exp_f32 v156, v156
    s_waitcnt lgkmcnt(4)
    v_mfma_f32_32x32x16_bf16 v[208:223], v[58:61], v[136:139], v[208:223]
    ds_read_b64_tr_b16 v[58:59], v9 offset:1536
    ds_read_b64_tr_b16 v[60:61], v9 offset:1600
    v_exp_f32 v157, v157
    v_exp_f32 v158, v158
    v_exp_f32 v159, v159
    v_cvt_pk_bf16_f32 v152, v152, v153
    v_cvt_pk_bf16_f32 v153, v154, v155
    v_cvt_pk_bf16_f32 v154, v156, v157
    v_cvt_pk_bf16_f32 v155, v158, v159
    v_exp_f32 v160, v160
    v_exp_f32 v161, v161
    v_exp_f32 v162, v162
    v_exp_f32 v163, v163
    v_exp_f32 v164, v164
    s_waitcnt lgkmcnt(4)
    v_mfma_f32_32x32x16_bf16 v[208:223], v[50:53], v[144:147], v[208:223]
    ds_read_b64_tr_b16 v[50:51], v9 offset:1664
    ds_read_b64_tr_b16 v[52:53], v9 offset:1728
    v_exp_f32 v165, v165
    v_exp_f32 v166, v166
    v_exp_f32 v167, v167
    v_cvt_pk_bf16_f32 v160, v160, v161
    v_cvt_pk_bf16_f32 v161, v162, v163
    v_cvt_pk_bf16_f32 v162, v164, v165
    v_cvt_pk_bf16_f32 v163, v166, v167
    v_exp_f32 v168, v168
    v_exp_f32 v169, v169
    v_exp_f32 v170, v170
    v_exp_f32 v171, v171
    v_exp_f32 v172, v172
    s_waitcnt lgkmcnt(4)
    v_mfma_f32_32x32x16_bf16 v[208:223], v[54:57], v[152:155], v[208:223]
    ds_read_b64_tr_b16 v[54:55], v9 offset:1792
    ds_read_b64_tr_b16 v[56:57], v9 offset:1856
    v_exp_f32 v173, v173
    v_exp_f32 v174, v174
    v_exp_f32 v175, v175
    v_cvt_pk_bf16_f32 v168, v168, v169
    v_cvt_pk_bf16_f32 v169, v170, v171
    v_cvt_pk_bf16_f32 v170, v172, v173
    v_cvt_pk_bf16_f32 v171, v174, v175
    v_exp_f32 v176, v176
    v_exp_f32 v177, v177
    v_exp_f32 v178, v178
    v_exp_f32 v179, v179
    v_exp_f32 v180, v180
    s_waitcnt lgkmcnt(4)
    v_mfma_f32_32x32x16_bf16 v[208:223], v[58:61], v[160:163], v[208:223]
    ds_read_b64_tr_b16 v[58:59], v9 offset:1920
    ds_read_b64_tr_b16 v[60:61], v9 offset:1984
    v_exp_f32 v181, v181
    v_exp_f32 v182, v182
    v_exp_f32 v183, v183
    v_cvt_pk_bf16_f32 v176, v176, v177
    v_cvt_pk_bf16_f32 v177, v178, v179
    v_cvt_pk_bf16_f32 v178, v180, v181
    v_cvt_pk_bf16_f32 v179, v182, v183
    v_exp_f32 v184, v184
    v_exp_f32 v185, v185
    v_exp_f32 v186, v186
    v_exp_f32 v187, v187
    v_exp_f32 v188, v188
    s_waitcnt lgkmcnt(4)
    v_mfma_f32_32x32x16_bf16 v[208:223], v[50:53], v[168:171], v[208:223]
    v_exp_f32 v189, v189
    v_exp_f32 v190, v190
    v_exp_f32 v191, v191
    v_cvt_pk_bf16_f32 v184, v184, v185
    v_cvt_pk_bf16_f32 v185, v186, v187
    v_cvt_pk_bf16_f32 v186, v188, v189
    v_cvt_pk_bf16_f32 v187, v190, v191
    s_waitcnt lgkmcnt(2)
    v_mfma_f32_32x32x16_bf16 v[208:223], v[54:57], v[176:179], v[208:223]
    s_waitcnt lgkmcnt(0)
    v_mfma_f32_32x32x16_bf16 v[208:223], v[58:61], v[184:187], v[208:223]
    v_mov_b32 v152, 1073741824
    v_mov_b32 v153, 1073741824
    v_mov_b32 v154, 1073741824
    v_mov_b32 v155, 1073741824
    v_mov_b32 v156, 1073741824
    v_mov_b32 v157, 1073741824
    v_mov_b32 v158, 1073741824
    v_mov_b32 v159, 1073741824
    s_lshl_b32 s3, s50, 4
    s_lshl_b32 s4, s44, 1
    s_add_u32 s3, s3, s4
    s_lshl_b32 s4, s3, 14
    s_lshl_b32 s5, s51, 9
    s_add_u32 s4, s4, s5
    s_add_u32 s90, s4, 9437184
    s_lshl_b32 s3, s3, 12
    s_lshl_b32 s5, s51, 7
    s_add_u32 s3, s3, s5
    s_add_u32 s91, s3, 11534336
    s_lshl_b32 s89, s2, 7
    s_branch L_att_done
L_end:
    s_endpgm
L_code_end:
.if (L_code_end-sequential_preLN__sliding_block__glu_gated_bilinear__prompt_kernel) < 40960
.fill (40960-(L_code_end-sequential_preLN__sliding_block__glu_gated_bilinear__prompt_kernel))/4, 4, 0xBF810000
.endif
.section .rodata,"a"
.p2align 6
.amdhsa_kernel sequential_preLN__sliding_block__glu_gated_bilinear__prompt_kernel
  .amdhsa_next_free_vgpr 256
  .amdhsa_next_free_sgpr 102
  .amdhsa_accum_offset 256
  .amdhsa_group_segment_fixed_size 0
  .amdhsa_kernarg_size 80
  .amdhsa_user_sgpr_count 2
  .amdhsa_user_sgpr_kernarg_segment_ptr 1
  .amdhsa_system_sgpr_workgroup_id_x 1
.end_amdhsa_kernel
```
